```python
import torch

def _softmax(x, axis=-1):
    return torch.softmax(x, dim=axis)
def _gelu(x):
    return torch.nn.functional.gelu(x, approximate="tanh")
def _silu(x):
    return torch.nn.functional.silu(x)
def _sigmoid(x):
    return torch.sigmoid(x)
def _layernorm(x, axis=-1, eps=1e-5):
    m = x.mean(dim=axis, keepdim=True)
    v = x.var(dim=axis, keepdim=True, unbiased=False)
    return (x - m) / torch.sqrt(v + eps)
def _scatter_add(tgt, idx, src, axis=0):
    return tgt.clone().index_add_(axis, idx, src)
def _segment_sum(src, seg, n):
    out = torch.zeros((n,) + src.shape[1:], dtype=src.dtype)
    return out.index_add_(0, seg, src)
def _pad(x, pw):
    flat = tuple(v for pair in reversed(pw) for v in pair)
    return torch.nn.functional.pad(x, flat)

kernel_name = 'sequential_preLN__grouped_kv_mqa__geglu_ffn__prompt'

def setup_inputs():

    _w = (lambda a: (lambda t: t.to(torch.bfloat16) if t.is_floating_point() else t)(torch.as_tensor(a)))
    def _A_setup():
        B, S, D, H = 1, 2048, 448, 16
        Dh = D // H
        return {
            "x": _w((lambda *s: torch.randn(*s, dtype=torch.bfloat16) * 0.05)(B, S, D)),
            "wq": _w((lambda *s: torch.randn(*s, dtype=torch.bfloat16) * 0.05)(D, H * Dh)),
            "wk": _w((lambda *s: torch.randn(*s, dtype=torch.bfloat16) * 0.05)(D, Dh)),
            "wv": _w((lambda *s: torch.randn(*s, dtype=torch.bfloat16) * 0.05)(D, Dh)),
            "wo": _w((lambda *s: torch.randn(*s, dtype=torch.bfloat16) * 0.05)(H * Dh, D)),
        }
    _A_in = _A_setup()

    def _B_setup():
        B, S, D, F = 1, 2048, 448, 1792
        return {
            "x": _w((lambda *s: torch.randn(*s, dtype=torch.bfloat16) * 0.05)(B, S, D)),
            "w_gate": _w((lambda *s: torch.randn(*s, dtype=torch.bfloat16) * 0.05)(D, F)),
            "w_up": _w((lambda *s: torch.randn(*s, dtype=torch.bfloat16) * 0.05)(D, F)),
            "w_down": _w((lambda *s: torch.randn(*s, dtype=torch.bfloat16) * 0.05)(F, D)),
        }
    _B_in = _B_setup()

    return {
        "A_x": _A_in["x"],
        "A_wq": _A_in["wq"],
        "A_wk": _A_in["wk"],
        "A_wv": _A_in["wv"],
        "A_wo": _A_in["wo"],
        "B_x": _B_in["x"],
        "B_w_gate": _B_in["w_gate"],
        "B_w_up": _B_in["w_up"],
        "B_w_down": _B_in["w_down"],
    }

def reference(A_x, A_wq, A_wk, A_wv, A_wo, B_x, B_w_gate, B_w_up, B_w_down):
    def _A_ref(x, wq, wk, wv, wo):
        B, S, D = x.shape
        H = 16
        Dh = D // H
        q = (lambda x, *d: x.permute(*d))((x @ wq).reshape(B, S, H, Dh), 0, 2, 1, 3)
        k = x @ wk
        v = x @ wv
        scores = torch.einsum("bhqd,bkd->bhqk", q, k) * (Dh ** -0.5)
        p = _softmax(scores, axis=-1)
        o = torch.einsum("bhqk,bkd->bhqd", p, v)
        return (lambda x, *d: x.permute(*d))(o, 0, 2, 1, 3).reshape(B, S, H * Dh) @ wo

    def _B_ref(x, w_gate, w_up, w_down):
        return (_gelu(x @ w_gate) * (x @ w_up)) @ w_down

    x = A_x
    h = x + _A_ref(_layernorm(x, axis=-1), A_wq, A_wk, A_wv, A_wo)
    h2 = h + _B_ref(_layernorm(h, axis=-1), B_w_gate, B_w_up, B_w_down)
    return h2
```

```asm
; @launch grid=(256,1,1) block=(256,1,1) lds=163840
.amdgcn_target "amdgcn-amd-amdhsa--gfx950"
.text
.globl sequential_preLN__grouped_kv_mqa__geglu_ffn__prompt_kernel
.p2align 12
.p2align 8
.type sequential_preLN__grouped_kv_mqa__geglu_ffn__prompt_kernel,@function
sequential_preLN__grouped_kv_mqa__geglu_ffn__prompt_kernel:
    s_cmp_ge_u32 s2, 256
    s_cbranch_scc1 L_exit
    s_load_dwordx16 s[4:19], s[0:1], 0
    s_load_dwordx8 s[20:27], s[0:1], 64
    s_and_b32 s29, s2, 7
    s_lshr_b32 s30, s2, 3
    s_getpc_b64 s[64:65]
L_pc0:
    s_lshl_b32 s3, s30, 11
    v_lshrrev_b32 v5, 4, v0
    v_lshl_add_u32 v5, v5, 7, s3
    s_mov_b32 s3, L_code_end-L_pc0-4
    v_min_u32 v5, s3, v5
    global_load_dword v255, v5, s[64:65]
    v_lshrrev_b32 v2, 6, v0
    v_and_b32 v0, 63, v0
    s_lshr_b32 s33, s30, 3
    s_lshl2_add_u32 s31, s29, s33
    s_and_b32 s32, s30, 7
    v_readfirstlane_b32 s28, v2
    v_lshlrev_b32 v1, 4, v0
    v_lshrrev_b32 v2, 3, v0
    v_mul_u32_u24 v2, 896, v2
    v_and_b32 v3, 0x70, v1
    v_add_u32 v50, v2, v3
    v_and_b32 v2, 0x30, v0
    v_xor_b32 v47, v50, v2
    s_movk_i32 s3, 6144
    v_xad_u32 v48, v47, 64, s3
    v_lshlrev_b32 v2, 2, v0
    v_and_b32 v2, 64, v2
    v_xor_b32 v49, v50, v2
    s_movk_i32 s55, 896
    s_cmp_eq_u32 s32, 7
    s_cselect_b64 vcc, -1, 0
    s_cselect_b32 s55, 56, s55
    v_cndmask_b32 v49, v49, v1, vcc
    s_and_b32 s3, s33, 1
    s_mul_i32 s3, s3, 3
    s_add_u32 s52, s32, s3
    s_add_u32 s52, s52, s29
    s_sub_u32 s3, s52, 7
    s_cselect_b32 s52, s52, s3
    s_sub_u32 s3, s52, 7
    s_cselect_b32 s52, s52, s3
    s_lshl2_add_u32 s56, s31, s28
    s_mul_i32 s56, s56, 16*896
    s_mul_i32 s57, s28, s55
    s_lshl_b32 s57, s57, 4
    s_lshl_b32 s55, s55, 6
    s_lshl_b32 s62, s32, 7
    s_sub_u32 s58, s57, 2048
    s_ashr_i32 s59, s58, 31
    s_sub_u32 s60, s57, 3072
    s_ashr_i32 s61, s60, 31
    s_lshl_b32 m0, s28, 12
    s_waitcnt lgkmcnt(0)
    s_add_u32 s36, s6, s62
    s_addc_u32 s37, s7, 0
    s_sub_u32 s40, 448*896, s62
    s_add_u32 s4, s4, s56
    s_addc_u32 s5, s5, 0
    s_and_b32 s5, s5, 0xffff
    s_movk_i32 s6, 16*896
    s_mov_b32 s7, 0x20000
    s_mov_b32 s24, s52
    s_lshl_b32 s56, s52, 7
    buffer_load_dwordx4 v47, s[4:7], s56 offen lds
    buffer_load_dwordx4 v48, s[4:7], s56 offen offset:1024 lds
    s_add_u32 s38, s36, 8*896
    s_addc_u32 s39, s37, 0
    s_sub_u32 s41, s40, 8*896
    s_mov_b32 s34, s12
    s_mov_b32 s35, s13
    s_cmp_eq_u32 s32, 7
    s_cselect_b64 s[36:37], s[8:9], s[36:37]
    s_cselect_b64 s[38:39], s[10:11], s[38:39]
    s_cselect_b32 s40, 448*56, s40
    s_cselect_b32 s41, 448*56, s41
    s_add_u32 s8, s36, s58
    s_addc_u32 s9, s37, s59
    s_and_b32 s9, s9, 0xffff
    s_sub_u32 s10, s40, s58
    s_mov_b32 s11, 0x20000
    s_add_u32 s12, s38, s60
    s_addc_u32 s13, s39, s61
    s_and_b32 s13, s13, 0xffff
    s_sub_u32 s14, s41, s60
    s_mov_b32 s15, 0x20000
    s_mul_i32 s57, s52, s55
    buffer_load_dwordx4 v49, s[8:11], s57 offen offset:2048 lds
    buffer_load_dwordx4 v49, s[12:15], s57 offen offset:3072 lds
    s_add_u32 m0, m0, 16384
    s_add_u32 s52, s52, 1
    s_cmp_eq_u32 s52, 7
    s_cselect_b32 s52, 0, s52
    s_lshl_b32 s56, s52, 7
    buffer_load_dwordx4 v47, s[4:7], s56 offen lds
    s_load_dwordx4 s[36:39], s[26:27], 36864
    s_load_dwordx2 s[40:41], s[26:27], 36880
    v_and_b32 v58, 15, v0
    v_lshrrev_b32 v53, 2, v58
    v_and_b32 v52, 3, v0
    v_bfe_u32 v54, v0, 4, 1
    v_lshrrev_b32 v55, 5, v0
    v_and_b32 v57, 31, v0
    v_lshl_add_u32 v56, v55, 3, v53
    v_lshrrev_b32 v59, 1, v58
    v_xor_b32 v59, v59, v55
    v_lshlrev_b32 v59, 4, v59
    buffer_load_dwordx4 v48, s[4:7], s56 offen offset:1024 lds
    v_lshl_or_b32 v59, v58, 7, v59
    v_lshl_add_u32 v59, v54, 12, v59
    s_lshr_b32 s3, s28, 1
    s_lshl_b32 s3, s3, 13
    s_lshl_b32 s62, s28, 5
    s_or_b32 s3, s3, s62
    v_xor_b32 v32, s3, v59
    v_xor_b32 v33, 32, v32
    v_xor_b32 v34, 64, v32
    v_xor_b32 v35, 0x60, v32
    s_mul_i32 s57, s52, s55
    buffer_load_dwordx4 v49, s[8:11], s57 offen offset:2048 lds
    v_lshl_add_u32 v58, v54, 2, v52
    s_and_b32 s63, s28, 1
    s_lshl_b32 s3, s63, 6
    v_lshl_or_b32 v36, v58, 3, s3
    v_lshlrev_b32 v59, 3, v0
    v_and_b32 v59, 64, v59
    v_xor_b32 v36, v36, v59
    v_lshl_add_u32 v36, v56, 7, v36
    v_min_u32 v58, 6, v58
    v_lshlrev_b32 v58, 3, v58
    buffer_load_dwordx4 v49, s[12:15], s57 offen offset:3072 lds
    s_add_u32 m0, m0, 16384
    s_add_u32 s52, s52, 1
    s_cmp_eq_u32 s52, 7
    s_cselect_b32 s52, 0, s52
    v_mad_u32_u24 v58, v56, 56, v58
    s_lshl_b32 s3, s63, 10
    v_add_u32 v58, s3, v58
    s_movk_i32 s62, 512
    s_cmp_eq_u32 s32, 7
    s_cselect_b32 s62, 224, s62
    v_cndmask_b32 v36, v36, v58, vcc
    s_lshl_b32 s3, s28, 12
    s_add_u32 s3, s3, 2048
    v_add_u32 v36, s3, v36
    s_lshl_b32 s56, s52, 7
    buffer_load_dwordx4 v47, s[4:7], s56 offen lds
    v_add_u32 v37, s62, v36
    v_xor_b32 v38, 4096, v36
    v_xor_b32 v39, 4096, v37
    v_xor_b32 v40, 8192, v36
    v_xor_b32 v41, 8192, v37
    v_xor_b32 v42, 12288, v36
    v_xor_b32 v43, 12288, v37
    v_mov_b32 v44, 0
    v_mov_b32 v45, 0
    v_mov_b32 v46, 0
    buffer_load_dwordx4 v48, s[4:7], s56 offen offset:1024 lds
    v_mov_b32 v51, 0x3f803f80
    s_lshl_b32 s3, s28, 9
    s_add_u32 s3, s3, 135168
    v_lshl_add_u32 v243, v0, 2, s3
    s_and_b32 s3, s28, 2
    s_lshl_b32 s3, s3, 9
    s_add_u32 s3, s3, 135168
    v_lshl_add_u32 v62, v57, 2, s3
    s_lshl_b32 s3, s63, 9
    s_add_u32 s3, s3, 135424
    v_lshl_add_u32 v63, v55, 4, s3
    s_mul_i32 s57, s52, s55
    buffer_load_dwordx4 v49, s[8:11], s57 offen offset:2048 lds
    s_lshr_b32 s62, s28, 1
    s_lshl1_add_u32 s3, s31, s62
    s_mul_i32 s3, s3, 14
    s_lshl1_add_u32 s64, s32, s63
    s_add_u32 s3, s3, s64
    s_lshl_b32 s3, s3, 11
    s_add_u32 s3, s3, 524288
    v_lshlrev_b32 v58, 5, v57
    v_lshl_add_u32 v58, v55, 4, v58
    v_add_u32 v58, s3, v58
    buffer_load_dwordx4 v49, s[12:15], s57 offen offset:3072 lds
    s_add_u32 m0, m0, 16384
    s_add_u32 s52, s52, 1
    s_cmp_eq_u32 s52, 7
    s_cselect_b32 s52, 0, s52
    s_lshr_b32 s3, s30, 3
    s_lshl3_add_u32 s3, s3, s29
    s_lshl2_add_u32 s3, s3, s28
    s_lshl_b32 s3, s3, 11
    s_add_u32 s3, s3, 262144
    v_add_u32 v59, s3, v1
    v_cndmask_b32 v240, v58, v59, vcc
    s_lshl_b32 s3, s62, 11
    s_add_u32 s3, s3, 137216
    v_lshlrev_b32 v58, 6, v57
    v_lshl_add_u32 v58, v55, 3, v58
    v_add_u32 v241, s3, v58
    v_lshlrev_b32 v58, 6, v56
    v_lshl_add_u32 v58, v54, 5, v58
    v_lshl_add_u32 v58, v52, 3, v58
    v_add_u32 v242, s3, v58
    s_lshl_b32 s44, s52, 7
    s_mul_i32 s45, s52, s55
    s_add_u32 s52, s52, 1
    s_cmp_eq_u32 s52, 7
    s_cselect_b32 s52, 0, s52
    s_lshl_b32 s46, s52, 7
    s_mul_i32 s47, s52, s55
    s_add_u32 s52, s52, 1
    s_cmp_eq_u32 s52, 7
    s_cselect_b32 s52, 0, s52
    s_lshl_b32 s48, s52, 7
    s_mul_i32 s49, s52, s55
    s_add_u32 s52, s52, 1
    s_cmp_eq_u32 s52, 7
    s_cselect_b32 s52, 0, s52
    s_lshl_b32 s50, s52, 7
    s_mul_i32 s51, s52, s55
    v_add_u32 v64, 0x10000, v32
    v_add_u32 v65, 0x10000, v33
    v_add_u32 v66, 0x10000, v34
    v_add_u32 v67, 0x10000, v35
    v_add_u32 v68, 0x10000, v36
    v_add_u32 v69, 0x10000, v37
    v_add_u32 v70, 0x10000, v38
    v_add_u32 v71, 0x10000, v39
    v_add_u32 v72, 0x10000, v40
    v_add_u32 v73, 0x10000, v41
    v_add_u32 v74, 0x10000, v42
    v_add_u32 v75, 0x10000, v43
    s_lshl2_add_u32 s3, s30, s28
    s_mul_i32 s3, s3, 896
    v_min_u32 v3, 6, v0
    v_lshl_add_u32 v3, v3, 7, s3
    v_min_u32 v3, 114688, v3
    s_lshl_b32 s59, s28, 10
    s_add_u32 s59, s59, 114688
    s_cmp_lt_u32 s2, 157
    s_cbranch_scc1 L_gu_1001
    s_mul_i32 s3, s28, 8*896
    s_movk_i32 s65, 32*896
    v_mov_b32 v60, v50
    s_cmp_ge_u32 s2, 236
    s_cbranch_scc1 L_wo_1002
    s_add_u32 s16, s20, s3
    s_addc_u32 s17, s21, 0
    s_sub_u32 s42, s2, 157
    s_movk_i32 s43, 56
    s_movk_i32 s62, 1171
    s_movk_i32 s64, 387
    s_branch L_pdone_1003
L_wo_1002:
    s_add_u32 s16, s34, s3
    s_addc_u32 s17, s35, 0
    s_sub_u32 s42, s2, 236
    s_movk_i32 s43, 14
    s_movk_i32 s62, 4682
    s_movk_i32 s64, 93
    s_branch L_pdone_1003
L_gu_1001:
    s_cmp_lt_u32 s28, 2
    s_cselect_b64 s[16:17], s[16:17], s[18:19]
    s_and_b32 s3, s28, 1
    s_mul_i32 s3, s3, 8*3584
    s_add_u32 s16, s16, s3
    s_addc_u32 s17, s17, 0
    v_lshrrev_b32 v60, 3, v0
    v_mul_u32_u24 v60, 3584-896, v60
    v_add_u32 v60, v60, v50
    s_mov_b32 s65, 16*3584
    s_mov_b32 s42, s2
    s_movk_i32 s43, 28
    s_movk_i32 s62, 2341
    s_movk_i32 s64, 779
L_pdone_1003:
    s_mul_i32 s42, s42, 5
    s_min_u32 s42, s42, s64
    s_mul_i32 s62, s42, s62
    s_lshr_b32 s62, s62, 16
    s_mul_i32 s3, s62, s43
    s_sub_u32 s63, s42, s3
    s_mov_b32 s18, s62
    s_mov_b32 s19, s63
    s_mov_b32 s20, s43
    s_lshl_b32 s62, s62, 7
    s_mul_i32 s3, s63, s65
    s_add_u32 s3, s3, s62
    v_add_u32 v244, s3, v60
    s_add_u32 s63, s63, 1
    s_cmp_eq_u32 s63, s43
    s_cselect_b32 s63, 0, s63
    s_cselect_b32 s3, 128, 0
    s_add_u32 s62, s62, s3
    s_mul_i32 s3, s63, s65
    s_add_u32 s3, s3, s62
    v_add_u32 v245, s3, v60
    s_add_u32 s63, s63, 1
    s_cmp_eq_u32 s63, s43
    s_cselect_b32 s63, 0, s63
    s_cselect_b32 s3, 128, 0
    s_add_u32 s62, s62, s3
    s_mul_i32 s3, s63, s65
    s_add_u32 s3, s3, s62
    v_add_u32 v246, s3, v60
    s_add_u32 s63, s63, 1
    s_cmp_eq_u32 s63, s43
    s_cselect_b32 s63, 0, s63
    s_cselect_b32 s3, 128, 0
    s_add_u32 s62, s62, s3
    s_mul_i32 s3, s63, s65
    s_add_u32 s3, s3, s62
    v_add_u32 v247, s3, v60
    s_add_u32 s63, s63, 1
    s_cmp_eq_u32 s63, s43
    s_cselect_b32 s63, 0, s63
    s_cselect_b32 s3, 128, 0
    s_add_u32 s62, s62, s3
    s_mul_i32 s3, s63, s65
    s_add_u32 s3, s3, s62
    v_add_u32 v248, s3, v60
    s_lshl_b32 s3, s2, 7
    s_lshl3_add_u32 s3, s28, s3
    s_add_u32 s3, s3, 65536
    v_mov_b32 v10, s3
    s_lshl_b32 s62, s29, 5
    s_add_u32 s62, s62, s30
    s_lshl_b32 s53, s62, 7
    s_lshl_b32 s63, s2, 3
    s_add_u32 s63, s63, 32768
    s_cmp_eq_u32 s28, 0
    s_cselect_b32 s3, s53, s63
    v_writelane_b32 v10, s3, 1
    s_lshl2_add_u32 s3, s31, s28
    s_lshl_b32 s3, s3, 7
    s_add_u32 s57, s3, 98304
    v_writelane_b32 v10, s57, 2
    s_cmp_lt_u32 s28, 2
    s_cselect_b32 s60, 3, 1
    s_cmp_eq_u32 s32, 7
    s_cselect_b32 s3, 4, 0
    s_or_b32 s60, s60, s3
    s_mov_b32 s61, 0
    s_mov_b32 s25, 1
    s_waitcnt lgkmcnt(0)
    s_branch L_body
.p2align 12
L_body:
    s_waitcnt vmcnt(8)
    s_barrier
    ds_read_b128 v[160:163], v32 offset:0
    ds_read_b64_tr_b16 v[192:193], v36 offset:0
    ds_read_b64_tr_b16 v[194:195], v37 offset:0
    ds_read_b128 v[168:171], v34 offset:0
    ds_read_b64_tr_b16 v[196:197], v38 offset:0
    ds_read_b64_tr_b16 v[198:199], v39 offset:0
    ds_read_b128 v[164:167], v33 offset:0
    ds_read_b64_tr_b16 v[200:201], v40 offset:0
    ds_read_b64_tr_b16 v[202:203], v41 offset:0
    ds_read_b128 v[172:175], v35 offset:0
    ds_read_b64_tr_b16 v[204:205], v42 offset:0
    ds_read_b64_tr_b16 v[206:207], v43 offset:0
    buffer_load_dwordx4 v47, s[4:7], s44 offen lds
    v_mov_b32 v13, v13
    buffer_load_dwordx4 v48, s[4:7], s44 offen offset:1024 lds
    v_mov_b32 v13, v13
    buffer_load_dwordx4 v49, s[8:11], s45 offen offset:2048 lds
    v_mov_b32 v13, v13
    buffer_load_dwordx4 v49, s[12:15], s45 offen offset:3072 lds
    s_add_u32 m0, m0, 16384
    v_mov_b32 v13, v13
    s_waitcnt lgkmcnt(6)
    v_dot2c_f32_bf16 v44, v51, v160
    v_dot2c_f32_bf16 v45, v160, v160
    v_dot2c_f32_bf16 v46, v51, v192
    v_dot2c_f32_bf16 v44, v51, v161
    v_dot2c_f32_bf16 v45, v161, v161
    v_dot2c_f32_bf16 v46, v51, v193
    buffer_load_dwordx4 v47, s[4:7], s46 offen lds
    v_dot2c_f32_bf16 v44, v51, v162
    v_dot2c_f32_bf16 v45, v162, v162
    v_dot2c_f32_bf16 v46, v51, v194
    v_dot2c_f32_bf16 v44, v51, v163
    v_dot2c_f32_bf16 v45, v163, v163
    v_dot2c_f32_bf16 v46, v51, v195
    v_dot2c_f32_bf16 v44, v51, v168
    v_dot2c_f32_bf16 v45, v168, v168
    v_dot2c_f32_bf16 v46, v51, v196
    v_dot2c_f32_bf16 v44, v51, v169
    v_dot2c_f32_bf16 v45, v169, v169
    v_dot2c_f32_bf16 v46, v51, v197
    buffer_load_dwordx4 v48, s[4:7], s46 offen offset:1024 lds
    v_dot2c_f32_bf16 v44, v51, v170
    v_dot2c_f32_bf16 v45, v170, v170
    v_dot2c_f32_bf16 v46, v51, v198
    v_dot2c_f32_bf16 v44, v51, v171
    v_dot2c_f32_bf16 v45, v171, v171
    v_dot2c_f32_bf16 v46, v51, v199
    s_waitcnt lgkmcnt(0)
    s_waitcnt vmcnt(10)
    s_barrier
    v_mfma_f32_32x32x16_bf16 v[16:31], v[192:195], v[160:163], 0
    s_mul_i32 s68, s36, 1664525
    ds_read_b128 v[176:179], v32 offset:16384
    ds_read_b64_tr_b16 v[224:225], v36 offset:16384
    ds_read_b64_tr_b16 v[226:227], v37 offset:16384
    buffer_load_dwordx4 v49, s[8:11], s47 offen offset:2048 lds
    v_mfma_f32_32x32x16_bf16 v[16:31], v[196:199], v[164:167], v[16:31]
    s_add_u32 s68, s68, s38
    ds_read_b128 v[184:187], v34 offset:16384
    ds_read_b64_tr_b16 v[228:229], v38 offset:16384
    ds_read_b64_tr_b16 v[230:231], v39 offset:16384
    v_mfma_f32_32x32x16_bf16 v[16:31], v[200:203], v[168:171], v[16:31]
    s_mul_i32 s68, s68, 1664525
    ds_read_b128 v[180:183], v33 offset:16384
    ds_read_b64_tr_b16 v[232:233], v40 offset:16384
    ds_read_b64_tr_b16 v[234:235], v41 offset:16384
    buffer_load_dwordx4 v49, s[12:15], s47 offen offset:3072 lds
    s_add_u32 m0, m0, 16384
    v_mfma_f32_32x32x16_bf16 v[16:31], v[204:207], v[172:175], v[16:31]
    s_add_u32 s68, s68, s40
    ds_read_b128 v[188:191], v35 offset:16384
    ds_read_b64_tr_b16 v[236:237], v42 offset:16384
    ds_read_b64_tr_b16 v[238:239], v43 offset:16384
    v_mov_b32 v13, v13
    s_waitcnt lgkmcnt(6)
    v_dot2c_f32_bf16 v44, v51, v176
    v_dot2c_f32_bf16 v45, v176, v176
    v_dot2c_f32_bf16 v46, v51, v224
    v_dot2c_f32_bf16 v44, v51, v177
    v_dot2c_f32_bf16 v45, v177, v177
    v_dot2c_f32_bf16 v46, v51, v225
    buffer_load_dwordx4 v47, s[4:7], s48 offen lds
    v_dot2c_f32_bf16 v44, v51, v178
    v_dot2c_f32_bf16 v45, v178, v178
    v_dot2c_f32_bf16 v46, v51, v226
    v_dot2c_f32_bf16 v44, v51, v179
    v_dot2c_f32_bf16 v45, v179, v179
    v_dot2c_f32_bf16 v46, v51, v227
    v_dot2c_f32_bf16 v44, v51, v184
    v_dot2c_f32_bf16 v45, v184, v184
    v_dot2c_f32_bf16 v46, v51, v228
    v_dot2c_f32_bf16 v44, v51, v185
    v_dot2c_f32_bf16 v45, v185, v185
    v_dot2c_f32_bf16 v46, v51, v229
    buffer_load_dwordx4 v48, s[4:7], s48 offen offset:1024 lds
    v_dot2c_f32_bf16 v44, v51, v186
    v_dot2c_f32_bf16 v45, v186, v186
    v_dot2c_f32_bf16 v46, v51, v230
    v_dot2c_f32_bf16 v44, v51, v187
    v_dot2c_f32_bf16 v45, v187, v187
    v_dot2c_f32_bf16 v46, v51, v231
    s_waitcnt lgkmcnt(0)
    s_waitcnt vmcnt(10)
    s_barrier
    v_mfma_f32_32x32x16_bf16 v[16:31], v[224:227], v[176:179], v[16:31]
    s_mul_i32 s68, s68, 1664525
    ds_read_b128 v[160:163], v32 offset:32768
    ds_read_b64_tr_b16 v[192:193], v36 offset:32768
    ds_read_b64_tr_b16 v[194:195], v37 offset:32768
    buffer_load_dwordx4 v49, s[8:11], s49 offen offset:2048 lds
    v_mfma_f32_32x32x16_bf16 v[16:31], v[228:231], v[180:183], v[16:31]
    s_add_u32 s68, s68, 1013904223
    ds_read_b128 v[168:171], v34 offset:32768
    ds_read_b64_tr_b16 v[196:197], v38 offset:32768
    ds_read_b64_tr_b16 v[198:199], v39 offset:32768
    v_mfma_f32_32x32x16_bf16 v[16:31], v[232:235], v[184:187], v[16:31]
    s_mul_i32 s69, s37, 22695477
    ds_read_b128 v[164:167], v33 offset:32768
    ds_read_b64_tr_b16 v[200:201], v40 offset:32768
    ds_read_b64_tr_b16 v[202:203], v41 offset:32768
    buffer_load_dwordx4 v49, s[12:15], s49 offen offset:3072 lds
    s_add_u32 m0, m0, 16384
    v_mfma_f32_32x32x16_bf16 v[16:31], v[236:239], v[188:191], v[16:31]
    s_add_u32 s69, s69, s39
    ds_read_b128 v[172:175], v35 offset:32768
    ds_read_b64_tr_b16 v[204:205], v42 offset:32768
    ds_read_b64_tr_b16 v[206:207], v43 offset:32768
    v_mov_b32 v13, v13
    s_waitcnt lgkmcnt(6)
    v_dot2c_f32_bf16 v44, v51, v160
    v_dot2c_f32_bf16 v45, v160, v160
    v_dot2c_f32_bf16 v46, v51, v192
    v_dot2c_f32_bf16 v44, v51, v161
    v_dot2c_f32_bf16 v45, v161, v161
    v_dot2c_f32_bf16 v46, v51, v193
    buffer_load_dwordx4 v47, s[4:7], s50 offen lds
    v_dot2c_f32_bf16 v44, v51, v162
    v_dot2c_f32_bf16 v45, v162, v162
    v_dot2c_f32_bf16 v46, v51, v194
    v_dot2c_f32_bf16 v44, v51, v163
    v_dot2c_f32_bf16 v45, v163, v163
    v_dot2c_f32_bf16 v46, v51, v195
    v_dot2c_f32_bf16 v44, v51, v168
    v_dot2c_f32_bf16 v45, v168, v168
    v_dot2c_f32_bf16 v46, v51, v196
    v_dot2c_f32_bf16 v44, v51, v169
    v_dot2c_f32_bf16 v45, v169, v169
    v_dot2c_f32_bf16 v46, v51, v197
    buffer_load_dwordx4 v48, s[4:7], s50 offen offset:1024 lds
    v_dot2c_f32_bf16 v44, v51, v170
    v_dot2c_f32_bf16 v45, v170, v170
    v_dot2c_f32_bf16 v46, v51, v198
    v_dot2c_f32_bf16 v44, v51, v171
    v_dot2c_f32_bf16 v45, v171, v171
    v_dot2c_f32_bf16 v46, v51, v199
    s_waitcnt lgkmcnt(0)
    s_waitcnt vmcnt(10)
    s_barrier
    v_mfma_f32_32x32x16_bf16 v[16:31], v[192:195], v[160:163], v[16:31]
    s_mul_i32 s69, s69, 22695477
    ds_read_b128 v[176:179], v32 offset:49152
    ds_read_b64_tr_b16 v[224:225], v36 offset:49152
    ds_read_b64_tr_b16 v[226:227], v37 offset:49152
    buffer_load_dwordx4 v49, s[8:11], s51 offen offset:2048 lds
    v_mfma_f32_32x32x16_bf16 v[16:31], v[196:199], v[164:167], v[16:31]
    s_add_u32 s69, s69, s41
    ds_read_b128 v[184:187], v34 offset:49152
    ds_read_b64_tr_b16 v[228:229], v38 offset:49152
    ds_read_b64_tr_b16 v[230:231], v39 offset:49152
    v_mfma_f32_32x32x16_bf16 v[16:31], v[200:203], v[168:171], v[16:31]
    s_mul_i32 s69, s69, 22695477
    ds_read_b128 v[180:183], v33 offset:49152
    ds_read_b64_tr_b16 v[232:233], v40 offset:49152
    ds_read_b64_tr_b16 v[234:235], v41 offset:49152
    buffer_load_dwordx4 v49, s[12:15], s51 offen offset:3072 lds
    s_mov_b32 m0, s59
    v_mfma_f32_32x32x16_bf16 v[16:31], v[204:207], v[172:175], v[16:31]
    s_add_u32 s69, s69, 1
    ds_read_b128 v[188:191], v35 offset:49152
    ds_read_b64_tr_b16 v[236:237], v42 offset:49152
    ds_read_b64_tr_b16 v[238:239], v43 offset:49152
    v_mov_b32 v13, v13
    s_waitcnt lgkmcnt(6)
    v_dot2c_f32_bf16 v44, v51, v176
    v_dot2c_f32_bf16 v45, v176, v176
    v_dot2c_f32_bf16 v46, v51, v224
    v_dot2c_f32_bf16 v44, v51, v177
    v_dot2c_f32_bf16 v45, v177, v177
    v_dot2c_f32_bf16 v46, v51, v225
    global_load_dword v3, v3, s[34:35]
    v_dot2c_f32_bf16 v44, v51, v178
    v_dot2c_f32_bf16 v45, v178, v178
    v_dot2c_f32_bf16 v46, v51, v226
    v_dot2c_f32_bf16 v44, v51, v179
    v_dot2c_f32_bf16 v45, v179, v179
    v_dot2c_f32_bf16 v46, v51, v227
    v_dot2c_f32_bf16 v44, v51, v184
    v_dot2c_f32_bf16 v45, v184, v184
    v_dot2c_f32_bf16 v46, v51, v228
    v_dot2c_f32_bf16 v44, v51, v185
    v_dot2c_f32_bf16 v45, v185, v185
    v_dot2c_f32_bf16 v46, v51, v229
    s_sub_u32 s3, s68, 1
    v_mov_b32 v14, s3
    v_mov_b32 v15, s69
    v_writelane_b32 v14, 0, 0
    v_writelane_b32 v15, 0, 0
    s_mov_b64 exec, s[60:61]
    global_store_dwordx2 v10, v[14:15], s[26:27] sc1
    s_mov_b64 exec, -1
    v_dot2c_f32_bf16 v44, v51, v186
    v_dot2c_f32_bf16 v45, v186, v186
    v_dot2c_f32_bf16 v46, v51, v230
    v_dot2c_f32_bf16 v44, v51, v187
    v_dot2c_f32_bf16 v45, v187, v187
    v_dot2c_f32_bf16 v46, v51, v231
    s_waitcnt lgkmcnt(0)
    s_waitcnt vmcnt(10)
    s_barrier
    v_mfma_f32_32x32x16_bf16 v[16:31], v[224:227], v[176:179], v[16:31]
    ds_read_b128 v[160:163], v64 offset:0
    ds_read_b64_tr_b16 v[192:193], v68 offset:0
    ds_read_b64_tr_b16 v[194:195], v69 offset:0
    v_mfma_f32_32x32x16_bf16 v[16:31], v[228:231], v[180:183], v[16:31]
    ds_read_b128 v[168:171], v66 offset:0
    ds_read_b64_tr_b16 v[196:197], v70 offset:0
    ds_read_b64_tr_b16 v[198:199], v71 offset:0
    v_mfma_f32_32x32x16_bf16 v[16:31], v[232:235], v[184:187], v[16:31]
    ds_read_b128 v[164:167], v65 offset:0
    ds_read_b64_tr_b16 v[200:201], v72 offset:0
    ds_read_b64_tr_b16 v[202:203], v73 offset:0
    v_mfma_f32_32x32x16_bf16 v[16:31], v[236:239], v[188:191], v[16:31]
    ds_read_b128 v[172:175], v67 offset:0
    ds_read_b64_tr_b16 v[204:205], v74 offset:0
    ds_read_b64_tr_b16 v[206:207], v75 offset:0
    v_mov_b32 v13, v13
    s_waitcnt lgkmcnt(6)
    v_dot2c_f32_bf16 v44, v51, v160
    v_dot2c_f32_bf16 v45, v160, v160
    v_dot2c_f32_bf16 v46, v51, v192
    v_dot2c_f32_bf16 v44, v51, v161
    v_dot2c_f32_bf16 v45, v161, v161
    v_dot2c_f32_bf16 v46, v51, v193
    global_load_lds_dwordx4 v244, s[16:17] nt
    s_add_u32 m0, m0, 4096
    v_dot2c_f32_bf16 v44, v51, v162
    v_dot2c_f32_bf16 v45, v162, v162
    v_dot2c_f32_bf16 v46, v51, v194
    v_dot2c_f32_bf16 v44, v51, v163
    v_dot2c_f32_bf16 v45, v163, v163
    v_dot2c_f32_bf16 v46, v51, v195
    v_dot2c_f32_bf16 v44, v51, v168
    v_dot2c_f32_bf16 v45, v168, v168
    v_dot2c_f32_bf16 v46, v51, v196
    v_dot2c_f32_bf16 v44, v51, v169
    v_dot2c_f32_bf16 v45, v169, v169
    v_dot2c_f32_bf16 v46, v51, v197
    v_dot2c_f32_bf16 v44, v51, v170
    v_dot2c_f32_bf16 v45, v170, v170
    v_dot2c_f32_bf16 v46, v51, v198
    v_dot2c_f32_bf16 v44, v51, v171
    v_dot2c_f32_bf16 v45, v171, v171
    v_dot2c_f32_bf16 v46, v51, v199
    s_waitcnt lgkmcnt(0)
    s_waitcnt vmcnt(7)
    s_barrier
    v_mfma_f32_32x32x16_bf16 v[16:31], v[192:195], v[160:163], v[16:31]
    ds_read_b128 v[176:179], v64 offset:16384
    ds_read_b64_tr_b16 v[224:225], v68 offset:16384
    ds_read_b64_tr_b16 v[226:227], v69 offset:16384
    v_mfma_f32_32x32x16_bf16 v[16:31], v[196:199], v[164:167], v[16:31]
    ds_read_b128 v[184:187], v66 offset:16384
    ds_read_b64_tr_b16 v[228:229], v70 offset:16384
    ds_read_b64_tr_b16 v[230:231], v71 offset:16384
    v_mfma_f32_32x32x16_bf16 v[16:31], v[200:203], v[168:171], v[16:31]
    ds_read_b128 v[180:183], v65 offset:16384
    ds_read_b64_tr_b16 v[232:233], v72 offset:16384
    ds_read_b64_tr_b16 v[234:235], v73 offset:16384
    v_mfma_f32_32x32x16_bf16 v[16:31], v[204:207], v[172:175], v[16:31]
    ds_read_b128 v[188:191], v67 offset:16384
    ds_read_b64_tr_b16 v[236:237], v74 offset:16384
    ds_read_b64_tr_b16 v[238:239], v75 offset:16384
    v_mov_b32 v13, v13
    s_waitcnt lgkmcnt(6)
    v_dot2c_f32_bf16 v44, v51, v176
    v_dot2c_f32_bf16 v45, v176, v176
    v_dot2c_f32_bf16 v46, v51, v224
    v_dot2c_f32_bf16 v44, v51, v177
    v_dot2c_f32_bf16 v45, v177, v177
    v_dot2c_f32_bf16 v46, v51, v225
    global_load_lds_dwordx4 v245, s[16:17] nt
    s_add_u32 m0, m0, 4096
    v_dot2c_f32_bf16 v44, v51, v178
    v_dot2c_f32_bf16 v45, v178, v178
    v_dot2c_f32_bf16 v46, v51, v226
    v_dot2c_f32_bf16 v44, v51, v179
    v_dot2c_f32_bf16 v45, v179, v179
    v_dot2c_f32_bf16 v46, v51, v227
    v_dot2c_f32_bf16 v44, v51, v184
    v_dot2c_f32_bf16 v45, v184, v184
    v_dot2c_f32_bf16 v46, v51, v228
    v_dot2c_f32_bf16 v44, v51, v185
    v_dot2c_f32_bf16 v45, v185, v185
    v_dot2c_f32_bf16 v46, v51, v229
    global_load_lds_dwordx4 v246, s[16:17] nt
    s_add_u32 m0, m0, 4096
    v_dot2c_f32_bf16 v44, v51, v186
    v_dot2c_f32_bf16 v45, v186, v186
    v_dot2c_f32_bf16 v46, v51, v230
    v_dot2c_f32_bf16 v44, v51, v187
    v_dot2c_f32_bf16 v45, v187, v187
    v_dot2c_f32_bf16 v46, v51, v231
    s_waitcnt lgkmcnt(0)
    s_waitcnt vmcnt(5)
    s_barrier
    v_mfma_f32_32x32x16_bf16 v[16:31], v[224:227], v[176:179], v[16:31]
    ds_read_b128 v[160:163], v64 offset:32768
    ds_read_b64_tr_b16 v[192:193], v68 offset:32768
    ds_read_b64_tr_b16 v[194:195], v69 offset:32768
    global_load_lds_dwordx4 v247, s[16:17] nt
    s_add_u32 m0, m0, 4096
    v_mfma_f32_32x32x16_bf16 v[16:31], v[228:231], v[180:183], v[16:31]
    ds_read_b128 v[168:171], v66 offset:32768
    ds_read_b64_tr_b16 v[196:197], v70 offset:32768
    ds_read_b64_tr_b16 v[198:199], v71 offset:32768
    v_mfma_f32_32x32x16_bf16 v[16:31], v[232:235], v[184:187], v[16:31]
    ds_read_b128 v[164:167], v65 offset:32768
    ds_read_b64_tr_b16 v[200:201], v72 offset:32768
    ds_read_b64_tr_b16 v[202:203], v73 offset:32768
    v_mfma_f32_32x32x16_bf16 v[16:31], v[236:239], v[188:191], v[16:31]
    ds_read_b128 v[172:175], v67 offset:32768
    ds_read_b64_tr_b16 v[204:205], v74 offset:32768
    ds_read_b64_tr_b16 v[206:207], v75 offset:32768
    v_mov_b32 v13, v13
    s_waitcnt lgkmcnt(6)
    v_dot2c_f32_bf16 v44, v51, v160
    v_dot2c_f32_bf16 v45, v160, v160
    v_dot2c_f32_bf16 v46, v51, v192
    v_dot2c_f32_bf16 v44, v51, v161
    v_dot2c_f32_bf16 v45, v161, v161
    v_dot2c_f32_bf16 v46, v51, v193
    global_load_lds_dwordx4 v248, s[16:17] nt
    s_add_u32 m0, m0, 4096
    v_dot2c_f32_bf16 v44, v51, v162
    v_dot2c_f32_bf16 v45, v162, v162
    v_dot2c_f32_bf16 v46, v51, v194
    v_dot2c_f32_bf16 v44, v51, v163
    v_dot2c_f32_bf16 v45, v163, v163
    v_dot2c_f32_bf16 v46, v51, v195
    v_dot2c_f32_bf16 v44, v51, v168
    v_dot2c_f32_bf16 v45, v168, v168
    v_dot2c_f32_bf16 v46, v51, v196
    v_dot2c_f32_bf16 v44, v51, v169
    v_dot2c_f32_bf16 v45, v169, v169
    v_dot2c_f32_bf16 v46, v51, v197
    v_dot2c_f32_bf16 v44, v51, v170
    v_dot2c_f32_bf16 v45, v170, v170
    v_dot2c_f32_bf16 v46, v51, v198
    v_dot2c_f32_bf16 v44, v51, v171
    v_dot2c_f32_bf16 v45, v171, v171
    v_dot2c_f32_bf16 v46, v51, v199
    s_waitcnt lgkmcnt(0)
    s_nop 1
    v_mov_b32 v58, v46
    v_permlane32_swap_b32 v44, v45
    s_nop 0
    v_permlane32_swap_b32 v46, v58
    v_add_f32 v44, v44, v45
    v_add_f32 v46, v46, v58
    ds_write2st64_b32 v243, v44, v46 offset1:1
    v_mfma_f32_32x32x16_bf16 v[16:31], v[192:195], v[160:163], v[16:31]
    v_mfma_f32_32x32x16_bf16 v[16:31], v[196:199], v[164:167], v[16:31]
    s_waitcnt lgkmcnt(0)
    s_barrier
    ds_read2_b32 v[44:45], v62 offset0:0 offset1:32
    ds_read2_b32 v[58:59], v62 offset0:128 offset1:160
    v_mfma_f32_32x32x16_bf16 v[16:31], v[200:203], v[168:171], v[16:31]
    ds_read_b128 v[176:179], v63 offset:0
    ds_read_b128 v[224:227], v63 offset:1024
    ds_read_b128 v[180:183], v63 offset:32
    ds_read_b128 v[228:231], v63 offset:1056
    v_mfma_f32_32x32x16_bf16 v[16:31], v[204:207], v[172:175], v[16:31]
    ds_read_b128 v[184:187], v63 offset:64
    ds_read_b128 v[232:235], v63 offset:1088
    ds_read_b128 v[188:191], v63 offset:96
    ds_read_b128 v[236:239], v63 offset:1120
    s_cmp_eq_u32 s32, 7
    s_cselect_b32 s3, 1.0, 0x3e8b97f6
    s_waitcnt lgkmcnt(8)
    v_add_f32 v44, v44, v58
    v_add_f32 v45, v45, v59
    v_mul_f32 v44, 0xbb124925, v44
    v_mul_f32 v45, 0x3b124925, v45
    v_fma_f32 v45, -v44, v44, v45
    v_max_f32 v45, 0, v45
    v_add_f32 v45, 0x3727c5ac, v45
    v_rsq_f32 v46, v45
    s_waitcnt lgkmcnt(6)
    v_pk_add_f32 v[176:177], v[176:177], v[224:225]
    v_pk_add_f32 v[178:179], v[178:179], v[226:227]
    s_waitcnt lgkmcnt(4)
    v_pk_add_f32 v[180:181], v[180:181], v[228:229]
    v_pk_add_f32 v[182:183], v[182:183], v[230:231]
    s_waitcnt lgkmcnt(2)
    v_pk_add_f32 v[184:185], v[184:185], v[232:233]
    v_pk_add_f32 v[186:187], v[186:187], v[234:235]
    s_waitcnt lgkmcnt(0)
    v_pk_add_f32 v[188:189], v[188:189], v[236:237]
    v_pk_add_f32 v[190:191], v[190:191], v[238:239]
    v_mul_f32 v46, s3, v46
    v_pk_fma_f32 v[176:177], v[44:45], v[176:177], v[16:17] op_sel_hi:[0,1,1]
    v_pk_fma_f32 v[178:179], v[44:45], v[178:179], v[18:19] op_sel_hi:[0,1,1]
    v_pk_fma_f32 v[180:181], v[44:45], v[180:181], v[20:21] op_sel_hi:[0,1,1]
    v_pk_fma_f32 v[182:183], v[44:45], v[182:183], v[22:23] op_sel_hi:[0,1,1]
    v_pk_fma_f32 v[184:185], v[44:45], v[184:185], v[24:25] op_sel_hi:[0,1,1]
    v_pk_fma_f32 v[186:187], v[44:45], v[186:187], v[26:27] op_sel_hi:[0,1,1]
    v_pk_fma_f32 v[188:189], v[44:45], v[188:189], v[28:29] op_sel_hi:[0,1,1]
    v_pk_fma_f32 v[190:191], v[44:45], v[190:191], v[30:31] op_sel_hi:[0,1,1]
    v_pk_mul_f32 v[176:177], v[46:47], v[176:177] op_sel_hi:[0,1]
    v_pk_mul_f32 v[178:179], v[46:47], v[178:179] op_sel_hi:[0,1]
    v_pk_mul_f32 v[180:181], v[46:47], v[180:181] op_sel_hi:[0,1]
    v_pk_mul_f32 v[182:183], v[46:47], v[182:183] op_sel_hi:[0,1]
    v_pk_mul_f32 v[184:185], v[46:47], v[184:185] op_sel_hi:[0,1]
    v_pk_mul_f32 v[186:187], v[46:47], v[186:187] op_sel_hi:[0,1]
    v_pk_mul_f32 v[188:189], v[46:47], v[188:189] op_sel_hi:[0,1]
    v_pk_mul_f32 v[190:191], v[46:47], v[190:191] op_sel_hi:[0,1]
    v_cvt_pk_bf16_f32 v192, v176, v177
    v_cvt_pk_bf16_f32 v193, v178, v179
    v_cvt_pk_bf16_f32 v194, v180, v181
    v_cvt_pk_bf16_f32 v195, v182, v183
    v_cvt_pk_bf16_f32 v196, v184, v185
    v_cvt_pk_bf16_f32 v197, v186, v187
    v_cvt_pk_bf16_f32 v198, v188, v189
    v_cvt_pk_bf16_f32 v199, v190, v191
    s_cmp_lg_u32 s32, 7
    s_cbranch_scc1 L_st_1004
    s_and_b32 s63, s28, 1
    s_mul_i32 s3, s63, 0x3f80
    s_mov_b32 exec_lo, 0
    v_mov_b32 v198, s3
    v_mov_b32 v199, 0
    s_mov_b32 exec_lo, -1
    s_cmp_eq_u32 s63, 0
    s_cbranch_scc1 L_st_1004
    ds_write_b64 v241, v[192:193] offset:0
    ds_write_b64 v241, v[194:195] offset:16
    ds_write_b64 v241, v[196:197] offset:32
    ds_write_b64 v241, v[198:199] offset:48
    ds_read_b64_tr_b16 v[192:193], v242 offset:0
    ds_read_b64_tr_b16 v[194:195], v242 offset:256
    ds_read_b64_tr_b16 v[196:197], v242 offset:1024
    ds_read_b64_tr_b16 v[198:199], v242 offset:1280
    s_waitcnt lgkmcnt(0)
L_st_1004:
    global_store_dwordx4 v240, v[192:195], s[26:27] sc1
    global_store_dwordx4 v240, v[196:199], s[26:27] offset:1024 sc1
    s_mov_b32 s4, s34
    s_and_b32 s5, s35, 0xffff
    s_mov_b32 s6, 114688
    s_mul_i32 s8, s28, 28672
    s_mul_i32 s9, s28, 0
    s_lshl_b32 s33, s29, 5
    s_add_u32 s33, s33, s30
    s_mul_i32 s3, s28, 98*1024
    s_add_u32 s3, s3, 2363392
    s_add_u32 s40, s26, s3
    s_addc_u32 s41, s27, 0
    s_and_b32 s3, s32, 1
    s_lshl_b32 s3, s3, 3
    v_and_b32 v58, 7, v0
    v_add_u32 v58, s3, v58
    v_lshlrev_b32 v59, 3, v58
    v_and_b32 v59, 0x70, v59
    v_lshl_or_b32 v59, v58, 7, v59
    s_lshr_b32 s3, s32, 1
    s_lshl_b32 s3, s3, 12
    v_or_b32 v59, s3, v59
    s_mul_i32 s64, s28, 7
    s_lshl_b32 s3, s24, 2
    s_sub_u32 s64, s64, s3
    s_cselect_b32 s3, 28, 0
    s_add_u32 s64, s64, s3
    v_lshrrev_b32 v58, 3, v0
    v_min_u32 v58, 6, v58
    v_add_u32 v58, s64, v58
    v_subrev_u32 v60, 28, v58
    v_min_u32 v58, v58, v60
    v_mul_u32_u24 v58, 4128, v58
    v_and_b32 v58, 0x1c060, v58
    v_xor_b32 v208, v58, v59
    v_xor_b32 v212, 16, v208
    ds_read_b128 v[208:211], v208
    ds_read_b128 v[212:215], v212
    s_mov_b64 exec, 0
    s_cmp_eq_u32 s28, 0
    s_cbranch_scc1 L_pad0
    s_cmp_eq_u32 s28, 1
    s_cbranch_scc1 L_pad1
    s_cmp_eq_u32 s28, 2
    s_cbranch_scc1 L_pad2
    s_cmp_eq_u32 s28, 3
    s_cbranch_scc1 L_pad3
L_back0:
    s_mov_b64 exec, -1
    s_waitcnt lgkmcnt(0)
    s_barrier
    s_add_u32 m0, s8, 0
    s_nop 0
    buffer_load_dwordx4 v1, s[4:7], m0 offen offset:0 lds
    buffer_load_dwordx4 v1, s[4:7], m0 offen offset:1024 lds
    buffer_load_dwordx4 v1, s[4:7], m0 offen offset:2048 lds
    buffer_load_dwordx4 v1, s[4:7], m0 offen offset:3072 lds
    v_and_b32 v58, 1, v52
    v_lshrrev_b32 v59, 1, v52
    v_lshl_or_b32 v58, v58, 1, v59
    v_lshlrev_b32 v58, 3, v58
    s_cmp_eq_u32 s20, 56
    s_cbranch_scc1 L_wd_1006
    s_cmp_eq_u32 s20, 28
    s_cbranch_scc1 L_gu_1005
    v_lshrrev_b32 v58, 1, v53
    v_and_b32 v59, 1, v53
    v_lshl_add_u32 v59, v58, 3, v59
    v_lshl_add_u32 v59, v54, 2, v59
    v_lshl_add_u32 v59, v55, 4, v59
    v_lshlrev_b32 v58, 3, v52
    s_mov_b32 s21, 2359296
    s_branch L_com_1007
L_gu_1005:
    v_lshl_add_u32 v59, v54, 4, v56
    s_mov_b32 s21, 2818048
L_com_1007:
    s_lshl_b32 s3, s28, 5
    s_add_u32 s3, s3, 114688
    v_lshl_add_u32 v58, v59, 7, v58
    v_add_u32 v254, s3, v58
    s_lshl2_add_u32 s3, s18, s28
    s_mul_i32 s3, s3, s20
    s_add_u32 s3, s3, s19
    s_lshl_b32 s3, s3, 10
    s_add_u32 s3, s3, s21
    v_add_u32 v249, s3, v1
    s_add_u32 s19, s19, 1
    s_cmp_eq_u32 s19, s20
    s_cselect_b32 s19, 0, s19
    s_addc_u32 s18, s18, 0
    s_lshl2_add_u32 s3, s18, s28
    s_mul_i32 s3, s3, s20
    s_add_u32 s3, s3, s19
    s_lshl_b32 s3, s3, 10
    s_add_u32 s3, s3, s21
    v_add_u32 v250, s3, v1
    s_add_u32 s19, s19, 1
    s_cmp_eq_u32 s19, s20
    s_cselect_b32 s19, 0, s19
    s_addc_u32 s18, s18, 0
    s_lshl2_add_u32 s3, s18, s28
    s_mul_i32 s3, s3, s20
    s_add_u32 s3, s3, s19
    s_lshl_b32 s3, s3, 10
    s_add_u32 s3, s3, s21
    v_add_u32 v251, s3, v1
    s_add_u32 s19, s19, 1
    s_cmp_eq_u32 s19, s20
    s_cselect_b32 s19, 0, s19
    s_addc_u32 s18, s18, 0
    s_lshl2_add_u32 s3, s18, s28
    s_mul_i32 s3, s3, s20
    s_add_u32 s3, s3, s19
    s_lshl_b32 s3, s3, 10
    s_add_u32 s3, s3, s21
    v_add_u32 v252, s3, v1
    s_add_u32 s19, s19, 1
    s_cmp_eq_u32 s19, s20
    s_cselect_b32 s19, 0, s19
    s_addc_u32 s18, s18, 0
    s_lshl2_add_u32 s3, s18, s28
    s_mul_i32 s3, s3, s20
    s_add_u32 s3, s3, s19
    s_lshl_b32 s3, s3, 10
    s_add_u32 s3, s3, s21
    v_add_u32 v253, s3, v1
    s_branch L_pdone_1008
L_wd_1006:
    s_lshr_b32 s43, s28, 1
    s_lshl_b32 s3, s43, 11
    s_and_b32 s65, s28, 1
    s_lshl_b32 s42, s65, 6
    s_add_u32 s3, s3, s42
    s_add_u32 s3, s3, 114688
    v_lshl_add_u32 v58, v54, 5, v58
    v_lshl_add_u32 v58, v56, 7, v58
    v_add_u32 v254, s3, v58
    s_lshl1_add_u32 s42, s19, s43
    s_mul_i32 s3, s42, 9363
    s_lshr_b32 s3, s3, 16
    s_mul_i32 s64, s3, 7
    s_sub_u32 s42, s42, s64
    s_and_b32 s64, s3, 3
    s_lshl2_add_u32 s42, s42, s64
    s_lshr_b32 s3, s3, 2
    s_lshl2_add_u32 s3, s18, s3
    s_mul_i32 s3, s3, 28
    s_add_u32 s3, s3, s42
    s_lshl1_add_u32 s3, s3, s65
    s_lshl_b32 s3, s3, 10
    s_add_u32 s3, s3, 6029312
    v_add_u32 v249, s3, v1
    s_add_u32 s19, s19, 1
    s_cmp_eq_u32 s19, s20
    s_cselect_b32 s19, 0, s19
    s_addc_u32 s18, s18, 0
    s_lshl1_add_u32 s42, s19, s43
    s_mul_i32 s3, s42, 9363
    s_lshr_b32 s3, s3, 16
    s_mul_i32 s64, s3, 7
    s_sub_u32 s42, s42, s64
    s_and_b32 s64, s3, 3
    s_lshl2_add_u32 s42, s42, s64
    s_lshr_b32 s3, s3, 2
    s_lshl2_add_u32 s3, s18, s3
    s_mul_i32 s3, s3, 28
    s_add_u32 s3, s3, s42
    s_lshl1_add_u32 s3, s3, s65
    s_lshl_b32 s3, s3, 10
    s_add_u32 s3, s3, 6029312
    v_add_u32 v250, s3, v1
    s_add_u32 s19, s19, 1
    s_cmp_eq_u32 s19, s20
    s_cselect_b32 s19, 0, s19
    s_addc_u32 s18, s18, 0
    s_lshl1_add_u32 s42, s19, s43
    s_mul_i32 s3, s42, 9363
    s_lshr_b32 s3, s3, 16
    s_mul_i32 s64, s3, 7
    s_sub_u32 s42, s42, s64
    s_and_b32 s64, s3, 3
    s_lshl2_add_u32 s42, s42, s64
    s_lshr_b32 s3, s3, 2
    s_lshl2_add_u32 s3, s18, s3
    s_mul_i32 s3, s3, 28
    s_add_u32 s3, s3, s42
    s_lshl1_add_u32 s3, s3, s65
    s_lshl_b32 s3, s3, 10
    s_add_u32 s3, s3, 6029312
    v_add_u32 v251, s3, v1
    s_add_u32 s19, s19, 1
    s_cmp_eq_u32 s19, s20
    s_cselect_b32 s19, 0, s19
    s_addc_u32 s18, s18, 0
    s_lshl1_add_u32 s42, s19, s43
    s_mul_i32 s3, s42, 9363
    s_lshr_b32 s3, s3, 16
    s_mul_i32 s64, s3, 7
    s_sub_u32 s42, s42, s64
    s_and_b32 s64, s3, 3
    s_lshl2_add_u32 s42, s42, s64
    s_lshr_b32 s3, s3, 2
    s_lshl2_add_u32 s3, s18, s3
    s_mul_i32 s3, s3, 28
    s_add_u32 s3, s3, s42
    s_lshl1_add_u32 s3, s3, s65
    s_lshl_b32 s3, s3, 10
    s_add_u32 s3, s3, 6029312
    v_add_u32 v252, s3, v1
    s_add_u32 s19, s19, 1
    s_cmp_eq_u32 s19, s20
    s_cselect_b32 s19, 0, s19
    s_addc_u32 s18, s18, 0
    s_lshl1_add_u32 s42, s19, s43
    s_mul_i32 s3, s42, 9363
    s_lshr_b32 s3, s3, 16
    s_mul_i32 s64, s3, 7
    s_sub_u32 s42, s42, s64
    s_and_b32 s64, s3, 3
    s_lshl2_add_u32 s42, s42, s64
    s_lshr_b32 s3, s3, 2
    s_lshl2_add_u32 s3, s18, s3
    s_mul_i32 s3, s3, 28
    s_add_u32 s3, s3, s42
    s_lshl1_add_u32 s3, s3, s65
    s_lshl_b32 s3, s3, 10
    s_add_u32 s3, s3, 6029312
    v_add_u32 v253, s3, v1
L_pdone_1008:
    s_movk_i32 s3, 512
    s_cmp_eq_u32 s20, 14
    s_cselect_b32 s3, 256, s3
    v_add_u32 v255, s3, v254
    s_lshl_b32 s3, s28, 10
    s_or_b32 s3, s3, 0x380
    v_and_b32 v58, 7, v0
    v_lshl_or_b32 v4, v58, 12, s3
    s_lshl2_add_u32 s56, s29, s28
    s_lshr_b32 s3, s30, 3
    s_lshl2_add_u32 s56, s56, s3
    s_lshl_b32 s56, s56, 7
    s_add_u32 s56, s56, 98304
    s_lshr_b32 s3, s33, 2
    s_mul_i32 s3, s3, 28672
    s_and_b32 s62, s33, 3
    s_lshl_b32 s62, s62, 8
    s_add_u32 s3, s3, s62
    s_add_u32 s3, s3, 524288
    v_lshrrev_b32 v58, 4, v0
    s_add_u32 m0, s8, 4096
    s_nop 0
    buffer_load_dwordx4 v1, s[4:7], m0 offen offset:0 lds
    v_and_b32 v59, 0xf0, v1
    v_lshl_add_u32 v58, v58, 10, v59
    v_add_u32 v58, s3, v58
    s_add_u32 s62, s28, 4
    s_min_u32 s62, s62, 6
    s_lshl3_add_u32 s54, s31, s28
    s_lshl_b32 s54, s54, 7
    s_lshl3_add_u32 s55, s31, s62
    s_lshl_b32 s55, s55, 7
    s_lshl_b32 s3, s28, 12
    v_add_u32 v2, s3, v58
    buffer_load_dwordx4 v1, s[4:7], m0 offen offset:1024 lds
    s_lshl_b32 s3, s62, 12
    s_waitcnt vmcnt(14)
    v_add_u32 v3, s3, v58
    s_lshl_b32 s60, s28, 10
    s_add_u32 s60, s60, 151552
    s_lshl_b32 s61, s62, 10
    s_add_u32 s61, s61, 151552
    s_lshl_b32 s3, s28, 16
    s_add_u32 s3, s3, 266240
    s_add_u32 s38, s26, s3
    s_addc_u32 s39, s27, 0
    buffer_load_dwordx4 v1, s[4:7], m0 offen offset:2048 lds
    buffer_load_dwordx4 v1, s[4:7], m0 offen offset:3072 lds
    s_add_u32 m0, s8, 8192
    s_nop 0
    buffer_load_dwordx4 v1, s[4:7], m0 offen offset:0 lds
    buffer_load_dwordx4 v1, s[4:7], m0 offen offset:1024 lds
    s_waitcnt vmcnt(10)
    s_waitcnt lgkmcnt(0)
    s_barrier
    s_cmp_lg_u32 s32, 7
    s_cbranch_scc1 L_nofk
    s_atomic_add s25, s[26:27], s57 offset:0
L_nofk:
    s_cmp_lg_u32 s28, 0
    s_cbranch_scc1 L_nf_2010
    s_atomic_add s25, s[26:27], s53 offset:0
L_nf_2010:
    buffer_load_dwordx4 v1, s[4:7], m0 offen offset:2048 lds
    buffer_load_dwordx4 v1, s[4:7], m0 offen offset:3072 lds
    s_add_u32 m0, s8, 12288
    s_nop 0
    buffer_load_dwordx4 v1, s[4:7], m0 offen offset:0 lds
    v_mov_b32 v5, 0xdddddddd
    v_add_u32 v12, 32768, v1
    v_mov_b64 v[16:17], 0
    v_mov_b64 v[18:19], 0
    v_bfe_u32 v11, v0, 3, 2
    v_mul_u32_u24 v11, 7, v11
    v_lshrrev_b32 v7, 5, v0
    v_add_u32 v6, v11, v7
    v_and_b32 v7, 7, v0
    buffer_load_dwordx4 v1, s[4:7], m0 offen offset:1024 lds
    v_lshlrev_b32 v7, 5, v7
    s_add_u32 s3, s28, 0
    s_and_b32 s3, s3, 3
L_pad0:
    s_cbranch_execz L_back0
    s_mul_i32 s3, s3, 1792
    s_add_u32 s62, s3, 151552
    s_add_u32 s3, s28, 1
    s_and_b32 s3, s3, 3
    s_mul_i32 s3, s3, 1792
    s_add_u32 s63, s3, 151552
    s_add_u32 s3, s28, 2
    s_and_b32 s3, s3, 3
    s_mul_i32 s3, s3, 1792
    s_add_u32 s64, s3, 151552
    s_add_u32 s3, s28, 3
    s_and_b32 s3, s3, 3
    s_mul_i32 s3, s3, 1792
    s_add_u32 s65, s3, 151552
    v_add_u32 v8, 0, v6
    buffer_load_dwordx4 v1, s[4:7], m0 offen offset:2048 lds
    v_lshrrev_b32 v9, 2, v8
    v_lshl_add_u32 v9, v9, 8, v7
    v_and_b32 v10, 1, v8
    v_lshl_add_u32 v9, v10, 4, v9
    v_bfe_u32 v10, v8, 1, 1
    v_lshl_add_u32 v9, v10, 3, v9
    v_add_u32 v128, s62, v9
    v_add_u32 v136, s63, v9
    v_add_u32 v144, s64, v9
    buffer_load_dwordx4 v1, s[4:7], m0 offen offset:3072 lds
    v_add_u32 v152, s65, v9
    v_add_u32 v8, 2, v6
    v_lshrrev_b32 v9, 2, v8
    v_lshl_add_u32 v9, v9, 8, v7
    v_and_b32 v10, 1, v8
    v_lshl_add_u32 v9, v10, 4, v9
    v_bfe_u32 v10, v8, 1, 1
    v_lshl_add_u32 v9, v10, 3, v9
    v_add_u32 v130, s62, v9
    s_add_u32 m0, s8, 16384
    s_nop 0
    buffer_load_dwordx4 v1, s[4:7], m0 offen offset:0 lds
    v_add_u32 v138, s63, v9
    v_add_u32 v146, s64, v9
    v_add_u32 v154, s65, v9
    v_add_u32 v8, 4, v6
    v_lshrrev_b32 v9, 2, v8
    v_lshl_add_u32 v9, v9, 8, v7
    v_and_b32 v10, 1, v8
    v_lshl_add_u32 v9, v10, 4, v9
    v_bfe_u32 v10, v8, 1, 1
    buffer_load_dwordx4 v1, s[4:7], m0 offen offset:1024 lds
    s_load_dwordx2 s[10:11], s[26:27], s54 glc
    s_load_dwordx2 s[12:13], s[26:27], s55 glc
    s_load_dwordx2 s[14:15], s[26:27], s56 glc
    v_lshl_add_u32 v9, v10, 3, v9
    v_add_u32 v132, s62, v9
    v_add_u32 v140, s63, v9
    v_add_u32 v148, s64, v9
    v_add_u32 v156, s65, v9
    v_add_u32 v8, 6, v11
    v_lshrrev_b32 v9, 2, v8
    v_lshl_add_u32 v9, v9, 8, v7
    v_and_b32 v10, 1, v8
    buffer_load_dwordx4 v1, s[4:7], m0 offen offset:2048 lds
    v_lshl_add_u32 v9, v10, 4, v9
    v_bfe_u32 v10, v8, 1, 1
    v_lshl_add_u32 v9, v10, 3, v9
    v_add_u32 v134, s62, v9
    v_add_u32 v142, s63, v9
    v_add_u32 v150, s64, v9
    v_add_u32 v158, s65, v9
    v_mfma_f32_32x32x16_bf16 v[64:79], v[16:19], v[16:19], 0
    v_mfma_f32_32x32x16_bf16 v[80:95], v[16:19], v[16:19], 0
    buffer_load_dwordx4 v1, s[4:7], m0 offen offset:3072 lds
    v_mfma_f32_32x32x16_bf16 v[96:111], v[16:19], v[16:19], 0
    v_mfma_f32_32x32x16_bf16 v[112:127], v[16:19], v[16:19], 0
    s_add_u32 s3, s28, 1
    s_and_b32 s3, s3, 3
    s_mul_i32 s3, s3, 12288
    s_add_u32 s3, s3, 86016
    v_add_u32 v6, s3, v1
    s_add_u32 s3, s28, 2
    s_and_b32 s3, s3, 3
    s_mul_i32 s3, s3, 12288
    s_add_u32 s3, s3, 90112
    v_add_u32 v7, s3, v1
    s_add_u32 m0, s8, 20480
    s_nop 0
    buffer_load_dwordx4 v1, s[4:7], m0 offen offset:0 lds
    s_add_u32 s3, s28, 3
    s_and_b32 s3, s3, 3
    s_mul_i32 s3, s3, 12288
    s_add_u32 s3, s3, 94208
    v_add_u32 v8, s3, v1
    s_mul_i32 s3, s28, 12288
    s_add_u32 s3, s3, 86016
    v_add_u32 v9, s3, v1
    s_lshr_b32 s34, s29, 1
    s_lshr_b32 s3, s30, 3
    s_lshl2_add_u32 s34, s34, s3
    s_and_b32 s35, s29, 1
    s_lshl3_add_u32 s35, s35, s32
    s_mul_i32 s3, s35, 7*28672
    s_add_u32 s3, s3, 2818048
    s_add_u32 s44, s26, s3
    s_addc_u32 s45, s27, 0
    s_and_b32 s45, s45, 0xffff
    s_mov_b32 s46, 5*28672
    s_mov_b32 s47, 0x20000
    s_add_u32 s48, s44, 5*28672
    s_addc_u32 s49, s45, 0
    s_mov_b32 s50, 2*28672
    s_mov_b32 s51, 0x20000
    s_mul_i32 s58, s28, 7168
    s_movk_i32 s59, 0x207
    buffer_load_dwordx4 v1, s[4:7], m0 offen offset:1024 lds
    buffer_load_dwordx4 v1, s[4:7], m0 offen offset:2048 lds
    buffer_load_dwordx4 v1, s[4:7], m0 offen offset:3072 lds
    s_add_u32 m0, s8, 24576
    s_nop 0
    buffer_load_dwordx4 v1, s[4:7], m0 offen offset:0 lds
    buffer_load_dwordx4 v1, s[4:7], m0 offen offset:1024 lds
    buffer_load_dwordx4 v1, s[4:7], m0 offen offset:2048 lds
    buffer_load_dwordx4 v1, s[4:7], m0 offen offset:3072 lds
    s_waitcnt lgkmcnt(0)
    s_xor_b64 s[10:11], s[10:11], s[68:69]
    s_xor_b64 s[12:13], s[12:13], s[68:69]
    s_or_b64 s[10:11], s[10:11], s[12:13]
    s_xor_b64 s[14:15], s[14:15], s[68:69]
    s_or_b64 s[10:11], s[10:11], s[14:15]
    s_cbranch_scc0 L_q_ok
    s_mov_b32 s3, 262144
L_poll_3011:
    s_load_dwordx2 s[10:11], s[26:27], s54 glc
    s_load_dwordx2 s[12:13], s[26:27], s55 glc
    s_load_dwordx2 s[14:15], s[26:27], s56 glc
    s_waitcnt lgkmcnt(0)
    s_xor_b64 s[10:11], s[10:11], s[68:69]
    s_xor_b64 s[12:13], s[12:13], s[68:69]
    s_or_b64 s[10:11], s[10:11], s[12:13]
    s_xor_b64 s[14:15], s[14:15], s[68:69]
    s_or_b64 s[10:11], s[10:11], s[14:15]
    s_cbranch_scc0 L_polld_3012
    s_sub_u32 s3, s3, 1
    s_cbranch_scc0 L_poll_3011
L_polld_3012:
L_q_ok:
    s_mov_b32 m0, s60
    s_nop 0
    global_load_lds_dwordx4 v2, s[26:27] sc1
    s_mov_b32 m0, s61
    s_nop 0
    global_load_lds_dwordx4 v3, s[26:27] sc1
    s_add_u32 s3, s29, 1
    s_and_b32 s3, s3, 7
    s_lshl2_add_u32 s3, s3, s28
    s_lshl_b32 s3, s3, 10
    s_or_b32 s3, s3, 0x380
    v_mov_b32 v63, s3
    s_add_u32 s3, s29, 0
    s_and_b32 s3, s3, 7
    s_lshl_b32 s3, s3, 13
    s_add_u32 s36, s38, s3
    s_addc_u32 s37, s39, 0
    global_load_dwordx4 v[200:203], v1, s[36:37] offset:-4096 sc1
    global_load_dwordx4 v[204:207], v1, s[36:37] offset:-3072 sc1
    global_load_dwordx4 v[192:195], v1, s[36:37] offset:-2048 sc1
    global_load_dwordx4 v[196:199], v1, s[36:37] offset:-1024 sc1
    global_load_dwordx2 v[14:15], v63, s[26:27] sc1
    ds_read_b64_tr_b16 v[240:241], v254 offset:0
    ds_read_b64_tr_b16 v[242:243], v255 offset:0
    ds_read_b64_tr_b16 v[244:245], v254 offset:4096
    ds_read_b64_tr_b16 v[246:247], v255 offset:4096
    ds_read_b64_tr_b16 v[232:233], v254 offset:8192
    ds_read_b64_tr_b16 v[234:235], v255 offset:8192
    ds_read_b64_tr_b16 v[236:237], v254 offset:12288
    ds_read_b64_tr_b16 v[238:239], v255 offset:12288
    ds_read_b64_tr_b16 v[224:225], v254 offset:16384
    ds_read_b64_tr_b16 v[226:227], v255 offset:16384
    v_lshrrev_b32 v59, 1, v53
    v_and_b32 v58, 1, v53
    v_lshl_add_u32 v58, v59, 3, v58
    v_lshl_add_u32 v58, v54, 2, v58
    v_lshl_add_u32 v58, v55, 4, v58
    v_mul_u32_u24 v58, 896, v58
    v_lshl_add_u32 v58, v52, 3, v58
    s_mul_i32 s3, s28, 224
    v_add_u32 v13, s3, v58
    v_and_b32 v58, 7, v0
    v_mul_u32_u24 v10, 960, v58
    v_bfe_u32 v3, v0, 3, 2
    v_mul_u32_u24 v3, 56, v3
    s_mul_i32 s3, s28, 224
    s_add_u32 s3, s3, 143360
    v_lshl_add_u32 v3, v55, 3, v3
    v_add3_u32 v2, v10, v3, s3
    v_cmp_eq_u32 vcc, 0, v55
    v_add_u32 v3, 48, v2
    v_mov_b32 v59, 151296
    v_cndmask_b32 v3, v59, v3, vcc
    v_lshrrev_b32 v59, 3, v0
    v_lshl_add_u32 v10, v59, 4, v10
    v_add_u32 v10, 143360, v10
    v_and_b32 v60, 1, v59
    v_mul_u32_u24 v60, 0xaaaa, v60
    v_add_u32 v218, 0x4444, v60
    s_add_u32 s3, s58, 117760
    v_min_u32 v59, 6, v59
    v_mul_u32_u24 v60, 464, v58
    v_lshl_add_u32 v60, v59, 6, v60
    v_add_u32 v217, s3, v60
    v_lshl_add_u32 v60, v54, 1, v55
    v_mul_u32_u24 v60, 928, v60
    v_and_b32 v61, 15, v0
    v_lshl_add_u32 v60, v61, 2, v60
    v_add_u32 v216, s3, v60
    v_lshlrev_b32 v222, 5, v58
    v_add_u32 v222, 151040, v222
    v_lshl_add_u32 v11, v55, 4, v222
    s_lshl_b32 s3, s28, 2
    v_add_u32 v11, s3, v11
    v_lshlrev_b32 v58, 4, v58
    v_lshl_add_u32 v58, v59, 10, v58
    s_lshr_b32 s63, s33, 2
    s_mul_i32 s63, s63, 28
    s_mul_i32 s62, s28, 7
    s_add_u32 s63, s63, s62
    s_lshl_b32 s63, s63, 10
    s_and_b32 s62, s33, 3
    s_lshl_b32 s62, s62, 7
    s_add_u32 s63, s63, s62
    s_add_u32 s63, s63, 7667712
    v_add_u32 v223, s63, v58
    v_add_u32 v219, 1835008, v223
    s_lshl_b32 s3, s2, 7
    s_lshl3_add_u32 s3, s28, s3
    s_add_u32 s3, s3, 65600
    s_lshl_b32 s20, s2, 3
    s_add_u32 s20, s20, 32768
    s_mov_b32 s21, s3
    v_lshlrev_b32 v220, 2, v0
    v_add_u32 v220, 158720, v220
    v_mov_b32 v58, 0
    ds_write2st64_b32 v220, v58, v58 offset1:1
    v_mov_b32 v221, 1
    s_waitcnt vmcnt(5) lgkmcnt(0)
    s_barrier
    ds_read_b64 v[136:137], v136
    ds_read_b64 v[138:139], v138
    ds_read_b64 v[140:141], v140
    ds_read_b64 v[142:143], v142
    global_load_dwordx4 v[184:187], v1, s[36:37] offset:0 sc1
    ds_read_b64 v[144:145], v144
    ds_read_b64 v[146:147], v146
    ds_read_b64 v[148:149], v148
    ds_read_b64 v[150:151], v150
    global_load_dwordx4 v[188:191], v1, s[36:37] offset:1024 sc1
    s_waitcnt vmcnt(6) lgkmcnt(6)
    v_mfma_f32_32x32x16_bf16 v[16:31], v[200:203], v[136:139], 0
    ds_read_b64 v[152:153], v152
    ds_read_b64 v[154:155], v154
    ds_read_b64 v[156:157], v156
    ds_read_b64 v[158:159], v158
    global_load_dwordx4 v[176:179], v1, s[36:37] offset:2048 sc1
    s_waitcnt vmcnt(6) lgkmcnt(8)
    v_mfma_f32_32x32x16_bf16 v[16:31], v[204:207], v[140:143], v[16:31]
    ds_read_b64 v[128:129], v128
    ds_read_b64 v[130:131], v130
    ds_read_b64 v[132:133], v132
    ds_read_b64 v[134:135], v134
    global_load_dwordx4 v[180:183], v1, s[36:37] offset:3072 sc1
    s_waitcnt vmcnt(4)
    v_cmp_ne_u64 vcc, s[68:69], v[14:15]
    s_cbranch_vccnz L_kv_spin
L_kv_ok:
    s_waitcnt lgkmcnt(10)
    v_mfma_f32_32x32x16_bf16 v[32:47], v[200:203], v[144:147], 0
    s_add_u32 s3, s29, 1
    s_and_b32 s3, s3, 7
    s_lshl_b32 s3, s3, 13
    ds_read_b64_tr_b16 a[0:1], v13 offset:0
    v_exp_f32 v16, v16
    v_exp_f32 v17, v17
    v_exp_f32 v18, v18
    v_exp_f32 v19, v19
    s_waitcnt lgkmcnt(9)
    v_mfma_f32_32x32x16_bf16 v[32:47], v[204:207], v[148:151], v[32:47]
    s_add_u32 s36, s38, s3
    s_addc_u32 s37, s39, 0
    ds_read_b64_tr_b16 a[2:3], v13 offset:1792
    v_exp_f32 v20, v20
    v_exp_f32 v21, v21
    v_exp_f32 v22, v22
    v_exp_f32 v23, v23
    global_load_dwordx4 v[168:171], v1, s[36:37] offset:-4096 sc1
    global_load_dwordx4 v[172:175], v1, s[36:37] offset:-3072 sc1
    v_exp_f32 v24, v24
    v_exp_f32 v25, v25
    v_exp_f32 v26, v26
    v_exp_f32 v27, v27
    v_exp_f32 v28, v28
    v_exp_f32 v29, v29
    v_exp_f32 v30, v30
    v_exp_f32 v31, v31
    s_waitcnt lgkmcnt(8)
    v_mfma_f32_32x32x16_bf16 v[48:63], v[200:203], v[152:155], 0
    ds_read_b64_tr_b16 a[8:9], v13 offset:32
    v_exp_f32 v32, v32
    v_exp_f32 v33, v33
    v_exp_f32 v34, v34
    v_exp_f32 v35, v35
    s_waitcnt lgkmcnt(7)
    v_mfma_f32_32x32x16_bf16 v[48:63], v[204:207], v[156:159], v[48:63]
    ds_read_b64_tr_b16 a[10:11], v13 offset:1824
    v_exp_f32 v36, v36
    v_exp_f32 v37, v37
    v_exp_f32 v38, v38
    v_exp_f32 v39, v39
    v_smfmac_f32_32x32x32_bf16 v[80:95], v[192:195], v[16:23], v5
    global_load_dwordx4 v[160:163], v1, s[36:37] offset:-2048 sc1
    global_load_dwordx4 v[164:167], v1, s[36:37] offset:-1024 sc1
    v_exp_f32 v40, v40
    v_exp_f32 v41, v41
    v_exp_f32 v42, v42
    v_exp_f32 v43, v43
    v_smfmac_f32_32x32x32_bf16 v[80:95], v[196:199], v[24:31], v5
    global_load_dwordx4 a[248:251], v1, s[36:37] offset:0 sc1
    v_exp_f32 v44, v44
    v_exp_f32 v45, v45
    v_exp_f32 v46, v46
    v_exp_f32 v47, v47
    s_waitcnt lgkmcnt(6)
    v_mfma_f32_32x32x16_bf16 v[16:31], v[200:203], v[128:131], 0
    ds_read_b64_tr_b16 a[16:17], v13 offset:64
    v_exp_f32 v48, v48
    v_exp_f32 v49, v49
    v_exp_f32 v50, v50
    v_exp_f32 v51, v51
    s_waitcnt lgkmcnt(5)
    v_mfma_f32_32x32x16_bf16 v[16:31], v[204:207], v[132:135], v[16:31]
    ds_read_b64_tr_b16 a[18:19], v13 offset:1856
    v_exp_f32 v52, v52
    v_exp_f32 v53, v53
    v_exp_f32 v54, v54
    v_exp_f32 v55, v55
    v_smfmac_f32_32x32x32_bf16 v[96:111], v[192:195], v[32:39], v5
    global_load_dwordx4 a[252:255], v1, s[36:37] offset:1024 sc1
    global_load_dwordx4 a[240:243], v1, s[36:37] offset:2048 sc1
    v_exp_f32 v56, v56
    v_exp_f32 v57, v57
    v_exp_f32 v58, v58
    v_exp_f32 v59, v59
    v_smfmac_f32_32x32x32_bf16 v[96:111], v[196:199], v[40:47], v5
    global_load_dwordx4 a[244:247], v1, s[36:37] offset:3072 sc1
    s_waitcnt vmcnt(10)
    v_exp_f32 v60, v60
    v_exp_f32 v61, v61
    v_exp_f32 v62, v62
    v_exp_f32 v63, v63
    v_mfma_f32_32x32x16_bf16 v[32:47], v[184:187], v[136:139], 0
    ds_read_b64_tr_b16 a[24:25], v13 offset:96
    v_exp_f32 v16, v16
    v_exp_f32 v17, v17
    v_exp_f32 v18, v18
    v_exp_f32 v19, v19
    v_mfma_f32_32x32x16_bf16 v[32:47], v[188:191], v[140:143], v[32:47]
    ds_read_b64_tr_b16 a[26:27], v13 offset:1888
    v_exp_f32 v20, v20
    v_exp_f32 v21, v21
    v_exp_f32 v22, v22
    v_exp_f32 v23, v23
    v_smfmac_f32_32x32x32_bf16 v[112:127], v[192:195], v[48:55], v5
    global_store_dwordx4 v249, v[240:243], s[26:27] sc1
    v_exp_f32 v24, v24
    v_exp_f32 v25, v25
    v_exp_f32 v26, v26
    v_exp_f32 v27, v27
    v_smfmac_f32_32x32x32_bf16 v[112:127], v[196:199], v[56:63], v5
    global_load_dwordx2 v[14:15], v4, s[26:27] sc1
    v_exp_f32 v28, v28
    v_exp_f32 v29, v29
    v_exp_f32 v30, v30
    v_exp_f32 v31, v31
    v_mfma_f32_32x32x16_bf16 v[48:63], v[184:187], v[144:147], 0
    ds_read_b64_tr_b16 a[32:33], v13 offset:128
    v_exp_f32 v32, v32
    v_exp_f32 v33, v33
    v_exp_f32 v34, v34
    v_exp_f32 v35, v35
    v_mfma_f32_32x32x16_bf16 v[48:63], v[188:191], v[148:151], v[48:63]
    ds_read_b64_tr_b16 a[34:35], v13 offset:1920
    v_exp_f32 v36, v36
    v_exp_f32 v37, v37
    v_exp_f32 v38, v38
    v_exp_f32 v39, v39
    v_smfmac_f32_32x32x32_bf16 v[64:79], v[192:195], v[16:23], v5
    global_store_dwordx4 v250, v[244:247], s[26:27] sc1
    v_exp_f32 v40, v40
    v_exp_f32 v41, v41
    v_exp_f32 v42, v42
    v_exp_f32 v43, v43
    v_smfmac_f32_32x32x32_bf16 v[64:79], v[196:199], v[24:31], v5
    v_exp_f32 v44, v44
    v_exp_f32 v45, v45
    v_exp_f32 v46, v46
    v_exp_f32 v47, v47
    v_mfma_f32_32x32x16_bf16 v[16:31], v[184:187], v[152:155], 0
    ds_read_b64_tr_b16 a[40:41], v13 offset:160
    v_exp_f32 v48, v48
    v_exp_f32 v49, v49
    v_exp_f32 v50, v50
    v_exp_f32 v51, v51
    v_mfma_f32_32x32x16_bf16 v[16:31], v[188:191], v[156:159], v[16:31]
    s_waitcnt vmcnt(11)
    ds_read_b64_tr_b16 a[42:43], v13 offset:1952
    v_exp_f32 v52, v52
    v_exp_f32 v53, v53
    v_exp_f32 v54, v54
    v_exp_f32 v55, v55
    v_smfmac_f32_32x32x32_bf16 v[80:95], v[176:179], v[32:39], v5
    global_store_dwordx4 v251, v[232:235], s[26:27] sc1
    v_exp_f32 v56, v56
    v_exp_f32 v57, v57
    v_exp_f32 v58, v58
    v_exp_f32 v59, v59
    v_smfmac_f32_32x32x32_bf16 v[80:95], v[180:183], v[40:47], v5
    v_exp_f32 v60, v60
    v_exp_f32 v61, v61
    v_exp_f32 v62, v62
    v_exp_f32 v63, v63
    v_mfma_f32_32x32x16_bf16 v[32:47], v[184:187], v[128:131], 0
    ds_read_b64_tr_b16 a[48:49], v13 offset:192
    v_exp_f32 v16, v16
    v_exp_f32 v17, v17
    v_exp_f32 v18, v18
    v_exp_f32 v19, v19
    v_mfma_f32_32x32x16_bf16 v[32:47], v[188:191], v[132:135], v[32:47]
    ds_read_b64_tr_b16 a[50:51], v13 offset:1984
    v_exp_f32 v20, v20
    v_exp_f32 v21, v21
    v_exp_f32 v22, v22
    v_exp_f32 v23, v23
    v_smfmac_f32_32x32x32_bf16 v[96:111], v[176:179], v[48:55], v5
    global_store_dwordx4 v252, v[236:239], s[26:27] sc1
    v_exp_f32 v24, v24
    v_exp_f32 v25, v25
    v_exp_f32 v26, v26
    v_exp_f32 v27, v27
    v_smfmac_f32_32x32x32_bf16 v[96:111], v[180:183], v[56:63], v5
    s_waitcnt vmcnt(11)
    v_exp_f32 v28, v28
    v_exp_f32 v29, v29
    v_exp_f32 v30, v30
    v_exp_f32 v31, v31
    v_mfma_f32_32x32x16_bf16 v[48:63], v[168:171], v[136:139], 0
    ds_read_b64_tr_b16 a[4:5], v13 offset:28672
    v_exp_f32 v32, v32
    v_exp_f32 v33, v33
    v_exp_f32 v34, v34
    v_exp_f32 v35, v35
    v_mfma_f32_32x32x16_bf16 v[48:63], v[172:175], v[140:143], v[48:63]
    ds_read_b64_tr_b16 a[6:7], v13 offset:30464
    v_exp_f32 v36, v36
    v_exp_f32 v37, v37
    v_exp_f32 v38, v38
    v_exp_f32 v39, v39
    v_smfmac_f32_32x32x32_bf16 v[112:127], v[176:179], v[16:23], v5
    global_store_dwordx4 v253, v[224:227], s[26:27] sc1
    v_exp_f32 v40, v40
    v_exp_f32 v41, v41
    v_exp_f32 v42, v42
    v_exp_f32 v43, v43
    v_smfmac_f32_32x32x32_bf16 v[112:127], v[180:183], v[24:31], v5
    v_exp_f32 v44, v44
    v_exp_f32 v45, v45
    v_exp_f32 v46, v46
    v_exp_f32 v47, v47
    v_mfma_f32_32x32x16_bf16 v[16:31], v[168:171], v[144:147], 0
    ds_read_b64_tr_b16 a[12:13], v13 offset:28704
    v_exp_f32 v48, v48
    v_exp_f32 v49, v49
    v_exp_f32 v50, v50
    v_exp_f32 v51, v51
    v_mfma_f32_32x32x16_bf16 v[16:31], v[172:175], v[148:151], v[16:31]
    ds_read_b64_tr_b16 a[14:15], v13 offset:30496
    v_exp_f32 v52, v52
    v_exp_f32 v53, v53
    v_exp_f32 v54, v54
    v_exp_f32 v55, v55
    v_smfmac_f32_32x32x32_bf16 v[64:79], v[176:179], v[32:39], v5
    v_exp_f32 v56, v56
    v_exp_f32 v57, v57
    v_exp_f32 v58, v58
    v_exp_f32 v59, v59
    v_smfmac_f32_32x32x32_bf16 v[64:79], v[180:183], v[40:47], v5
    v_exp_f32 v60, v60
    v_exp_f32 v61, v61
    v_exp_f32 v62, v62
    v_exp_f32 v63, v63
    v_mfma_f32_32x32x16_bf16 v[32:47], v[168:171], v[152:155], 0
    ds_read_b64_tr_b16 a[20:21], v13 offset:28736
    v_exp_f32 v16, v16
    v_exp_f32 v17, v17
    v_exp_f32 v18, v18
    v_exp_f32 v19, v19
    v_mfma_f32_32x32x16_bf16 v[32:47], v[172:175], v[156:159], v[32:47]
    s_waitcnt vmcnt(10)
    ds_read_b64_tr_b16 a[22:23], v13 offset:30528
    v_exp_f32 v20, v20
    v_exp_f32 v21, v21
    v_exp_f32 v22, v22
    v_exp_f32 v23, v23
    v_smfmac_f32_32x32x32_bf16 v[80:95], v[160:163], v[48:55], v5
    v_exp_f32 v24, v24
    v_exp_f32 v25, v25
    v_exp_f32 v26, v26
    v_exp_f32 v27, v27
    v_smfmac_f32_32x32x32_bf16 v[80:95], v[164:167], v[56:63], v5
    v_exp_f32 v28, v28
    v_exp_f32 v29, v29
    v_exp_f32 v30, v30
    v_exp_f32 v31, v31
    v_mfma_f32_32x32x16_bf16 v[48:63], v[168:171], v[128:131], 0
    ds_read_b64_tr_b16 a[28:29], v13 offset:28768
    v_exp_f32 v32, v32
    v_exp_f32 v33, v33
    v_exp_f32 v34, v34
    v_exp_f32 v35, v35
    v_mfma_f32_32x32x16_bf16 v[48:63], v[172:175], v[132:135], v[48:63]
    ds_read_b64_tr_b16 a[30:31], v13 offset:30560
    v_exp_f32 v36, v36
    v_exp_f32 v37, v37
    v_exp_f32 v38, v38
    v_exp_f32 v39, v39
    v_smfmac_f32_32x32x32_bf16 v[96:111], v[160:163], v[16:23], v5
    s_waitcnt vmcnt(4)
    v_cmp_ne_u64 vcc, s[68:69], v[14:15]
    v_exp_f32 v40, v40
    v_exp_f32 v41, v41
    v_exp_f32 v42, v42
    v_exp_f32 v43, v43
    v_smfmac_f32_32x32x32_bf16 v[96:111], v[164:167], v[24:31], v5
    s_cbranch_vccnz L_kv2_spin
L_kv2_ok:
    v_exp_f32 v44, v44
    v_exp_f32 v45, v45
    v_exp_f32 v46, v46
    v_exp_f32 v47, v47
    v_mfma_f32_32x32x16_bf16 v[16:31], a[248:251], v[136:139], 0
    s_add_u32 s3, s29, 2
    s_and_b32 s3, s3, 7
    s_lshl_b32 s3, s3, 13
    ds_read_b64_tr_b16 a[36:37], v13 offset:28800
    v_exp_f32 v48, v48
    v_exp_f32 v49, v49
    v_exp_f32 v50, v50
    v_exp_f32 v51, v51
    v_mfma_f32_32x32x16_bf16 v[16:31], a[252:255], v[140:143], v[16:31]
    s_add_u32 s36, s38, s3
    s_addc_u32 s37, s39, 0
    ds_read_b64_tr_b16 a[38:39], v13 offset:30592
    v_exp_f32 v52, v52
    v_exp_f32 v53, v53
    v_exp_f32 v54, v54
    v_exp_f32 v55, v55
    v_smfmac_f32_32x32x32_bf16 v[112:127], v[160:163], v[32:39], v5
    global_load_dwordx4 v[168:171], v1, s[36:37] offset:-4096 sc1
    global_load_dwordx4 v[172:175], v1, s[36:37] offset:-3072 sc1
    v_exp_f32 v56, v56
    v_exp_f32 v57, v57
    v_exp_f32 v58, v58
    v_exp_f32 v59, v59
    v_smfmac_f32_32x32x32_bf16 v[112:127], v[164:167], v[40:47], v5
    global_load_dwordx4 v[176:179], v1, s[36:37] offset:-2048 sc1
    v_exp_f32 v60, v60
    v_exp_f32 v61, v61
    v_exp_f32 v62, v62
    v_exp_f32 v63, v63
    v_mfma_f32_32x32x16_bf16 v[32:47], a[248:251], v[144:147], 0
    ds_read_b64_tr_b16 a[44:45], v13 offset:28832
    v_exp_f32 v16, v16
    v_exp_f32 v17, v17
    v_exp_f32 v18, v18
    v_exp_f32 v19, v19
    v_mfma_f32_32x32x16_bf16 v[32:47], a[252:255], v[148:151], v[32:47]
    ds_read_b64_tr_b16 a[46:47], v13 offset:30624
    v_exp_f32 v20, v20
    v_exp_f32 v21, v21
    v_exp_f32 v22, v22
    v_exp_f32 v23, v23
    v_smfmac_f32_32x32x32_bf16 v[64:79], v[160:163], v[48:55], v5
    global_load_dwordx4 v[180:183], v1, s[36:37] offset:-1024 sc1
    global_load_dwordx4 v[184:187], v1, s[36:37] offset:0 sc1
    v_exp_f32 v24, v24
    v_exp_f32 v25, v25
    v_exp_f32 v26, v26
    v_exp_f32 v27, v27
    v_smfmac_f32_32x32x32_bf16 v[64:79], v[164:167], v[56:63], v5
    global_load_dwordx4 v[188:191], v1, s[36:37] offset:1024 sc1
    v_exp_f32 v28, v28
    v_exp_f32 v29, v29
    v_exp_f32 v30, v30
    v_exp_f32 v31, v31
    v_mfma_f32_32x32x16_bf16 v[48:63], a[248:251], v[152:155], 0
    ds_read_b64_tr_b16 a[52:53], v13 offset:28864
    v_exp_f32 v32, v32
    v_exp_f32 v33, v33
    v_exp_f32 v34, v34
    v_exp_f32 v35, v35
    v_mfma_f32_32x32x16_bf16 v[48:63], a[252:255], v[156:159], v[48:63]
    ds_read_b64_tr_b16 a[54:55], v13 offset:30656
    v_add_u32 v13, 57344, v13
    v_exp_f32 v36, v36
    v_exp_f32 v37, v37
    v_exp_f32 v38, v38
    v_exp_f32 v39, v39
    v_smfmac_f32_32x32x32_bf16 v[80:95], a[240:243], v[16:23], v5
    global_load_dwordx4 v[160:163], v1, s[36:37] offset:2048 sc1
    global_load_dwordx4 v[164:167], v1, s[36:37] offset:3072 sc1
    v_exp_f32 v40, v40
    v_exp_f32 v41, v41
    v_exp_f32 v42, v42
    v_exp_f32 v43, v43
    v_smfmac_f32_32x32x32_bf16 v[80:95], a[244:247], v[24:31], v5
    v_exp_f32 v44, v44
    v_exp_f32 v45, v45
    v_exp_f32 v46, v46
    v_exp_f32 v47, v47
    v_mfma_f32_32x32x16_bf16 v[16:31], a[248:251], v[128:131], 0
    s_add_u32 s3, s29, 3
    s_and_b32 s3, s3, 7
    s_lshl_b32 s3, s3, 13
    ds_read_b64_tr_b16 a[56:57], v13 offset:0
    v_exp_f32 v48, v48
    v_exp_f32 v49, v49
    v_exp_f32 v50, v50
    v_exp_f32 v51, v51
    v_mfma_f32_32x32x16_bf16 v[16:31], a[252:255], v[132:135], v[16:31]
    s_add_u32 s36, s38, s3
    s_addc_u32 s37, s39, 0
    ds_read_b64_tr_b16 a[58:59], v13 offset:1792
    v_exp_f32 v52, v52
    v_exp_f32 v53, v53
    v_exp_f32 v54, v54
    v_exp_f32 v55, v55
    v_smfmac_f32_32x32x32_bf16 v[96:111], a[240:243], v[32:39], v5
    global_load_dwordx4 v[192:195], v1, s[36:37] offset:-4096 sc1
    global_load_dwordx4 v[196:199], v1, s[36:37] offset:-3072 sc1
    v_exp_f32 v56, v56
    v_exp_f32 v57, v57
    v_exp_f32 v58, v58
    v_exp_f32 v59, v59
    v_smfmac_f32_32x32x32_bf16 v[96:111], a[244:247], v[40:47], v5
    s_waitcnt vmcnt(10)
    ds_add_rtn_u32 v14, v220, v221
    s_waitcnt vmcnt(8)
    v_exp_f32 v60, v60
    v_exp_f32 v61, v61
    v_exp_f32 v62, v62
    v_exp_f32 v63, v63
    v_mfma_f32_32x32x16_bf16 v[32:47], v[168:171], v[136:139], 0
    ds_read_b64_tr_b16 a[64:65], v13 offset:32
    v_exp_f32 v16, v16
    v_exp_f32 v17, v17
    v_exp_f32 v18, v18
    v_exp_f32 v19, v19
    v_mfma_f32_32x32x16_bf16 v[32:47], v[172:175], v[140:143], v[32:47]
    ds_read_b64_tr_b16 a[66:67], v13 offset:1824
    s_waitcnt lgkmcnt(2)
    v_readfirstlane_b32 s62, v14
    v_exp_f32 v20, v20
    v_exp_f32 v21, v21
    v_exp_f32 v22, v22
    v_exp_f32 v23, v23
    v_smfmac_f32_32x32x32_bf16 v[112:127], a[240:243], v[48:55], v5
    global_load_dwordx4 a[248:251], v1, s[36:37] offset:-2048 sc1
    global_load_dwordx4 a[252:255], v1, s[36:37] offset:-1024 sc1
    v_exp_f32 v24, v24
    v_exp_f32 v25, v25
    v_exp_f32 v26, v26
    v_exp_f32 v27, v27
    v_smfmac_f32_32x32x32_bf16 v[112:127], a[244:247], v[56:63], v5
    s_cmp_eq_u32 s62, 3
    s_cselect_b32 s62, s20, s21
    s_atomic_add s25, s[26:27], s62
    v_exp_f32 v28, v28
    v_exp_f32 v29, v29
    v_exp_f32 v30, v30
    v_exp_f32 v31, v31
    v_mfma_f32_32x32x16_bf16 v[48:63], v[168:171], v[144:147], 0
    ds_read_b64_tr_b16 a[72:73], v13 offset:64
    v_exp_f32 v32, v32
    v_exp_f32 v33, v33
    v_exp_f32 v34, v34
    v_exp_f32 v35, v35
    v_mfma_f32_32x32x16_bf16 v[48:63], v[172:175], v[148:151], v[48:63]
    ds_read_b64_tr_b16 a[74:75], v13 offset:1856
    v_exp_f32 v36, v36
    v_exp_f32 v37, v37
    v_exp_f32 v38, v38
    v_exp_f32 v39, v39
    v_smfmac_f32_32x32x32_bf16 v[64:79], a[240:243], v[16:23], v5
    global_load_dwordx4 v[224:227], v1, s[36:37] offset:0 sc1
    global_load_dwordx4 v[228:231], v1, s[36:37] offset:1024 sc1
    v_exp_f32 v40, v40
    v_exp_f32 v41, v41
    v_exp_f32 v42, v42
    v_exp_f32 v43, v43
    v_smfmac_f32_32x32x32_bf16 v[64:79], a[244:247], v[24:31], v5
    global_load_dwordx4 v[232:235], v1, s[36:37] offset:2048 sc1
    v_exp_f32 v44, v44
    v_exp_f32 v45, v45
    v_exp_f32 v46, v46
    v_exp_f32 v47, v47
    v_mfma_f32_32x32x16_bf16 v[16:31], v[168:171], v[152:155], 0
    ds_read_b64_tr_b16 a[80:81], v13 offset:96
    v_exp_f32 v48, v48
    v_exp_f32 v49, v49
    v_exp_f32 v50, v50
    v_exp_f32 v51, v51
    v_mfma_f32_32x32x16_bf16 v[16:31], v[172:175], v[156:159], v[16:31]
    s_waitcnt vmcnt(11)
    ds_read_b64_tr_b16 a[82:83], v13 offset:1888
    v_exp_f32 v52, v52
    v_exp_f32 v53, v53
    v_exp_f32 v54, v54
    v_exp_f32 v55, v55
    v_smfmac_f32_32x32x32_bf16 v[80:95], v[176:179], v[32:39], v5
    global_load_dwordx4 v[236:239], v1, s[36:37] offset:3072 sc1
    s_add_u32 s3, s29, 4
    s_and_b32 s3, s3, 7
    s_lshl_b32 s3, s3, 13
    s_add_u32 s36, s38, s3
    s_addc_u32 s37, s39, 0
    v_exp_f32 v56, v56
    v_exp_f32 v57, v57
    v_exp_f32 v58, v58
    v_exp_f32 v59, v59
    v_smfmac_f32_32x32x32_bf16 v[80:95], v[180:183], v[40:47], v5
L_pad1:
    s_cbranch_execz L_back0
    global_load_dwordx4 a[240:243], v1, s[36:37] offset:-4096 sc1
    v_exp_f32 v60, v60
    v_exp_f32 v61, v61
    v_exp_f32 v62, v62
    v_exp_f32 v63, v63
    v_mfma_f32_32x32x16_bf16 v[32:47], v[168:171], v[128:131], 0
    ds_read_b64_tr_b16 a[88:89], v13 offset:128
    v_exp_f32 v16, v16
    v_exp_f32 v17, v17
    v_exp_f32 v18, v18
    v_exp_f32 v19, v19
    v_mfma_f32_32x32x16_bf16 v[32:47], v[172:175], v[132:135], v[32:47]
    ds_read_b64_tr_b16 a[90:91], v13 offset:1920
    v_exp_f32 v20, v20
    v_exp_f32 v21, v21
    v_exp_f32 v22, v22
    v_exp_f32 v23, v23
    v_smfmac_f32_32x32x32_bf16 v[96:111], v[176:179], v[48:55], v5
    global_load_dwordx4 a[244:247], v1, s[36:37] offset:-3072 sc1
    global_load_dwordx4 v[240:243], v1, s[36:37] offset:-2048 sc1
    v_exp_f32 v24, v24
    v_exp_f32 v25, v25
    v_exp_f32 v26, v26
    v_exp_f32 v27, v27
    v_smfmac_f32_32x32x32_bf16 v[96:111], v[180:183], v[56:63], v5
    global_load_dwordx4 v[244:247], v1, s[36:37] offset:-1024 sc1
    s_waitcnt vmcnt(14)
    v_exp_f32 v28, v28
    v_exp_f32 v29, v29
    v_exp_f32 v30, v30
    v_exp_f32 v31, v31
    v_mfma_f32_32x32x16_bf16 v[48:63], v[184:187], v[136:139], 0
    ds_read_b64_tr_b16 a[96:97], v13 offset:160
    v_exp_f32 v32, v32
    v_exp_f32 v33, v33
    v_exp_f32 v34, v34
    v_exp_f32 v35, v35
    v_mfma_f32_32x32x16_bf16 v[48:63], v[188:191], v[140:143], v[48:63]
    ds_read_b64_tr_b16 a[98:99], v13 offset:1952
    v_exp_f32 v36, v36
    v_exp_f32 v37, v37
    v_exp_f32 v38, v38
    v_exp_f32 v39, v39
    v_smfmac_f32_32x32x32_bf16 v[112:127], v[176:179], v[16:23], v5
    global_load_dwordx4 v[168:171], v1, s[36:37] offset:0 sc1
    global_load_dwordx4 v[172:175], v1, s[36:37] offset:1024 sc1
    v_exp_f32 v40, v40
    v_exp_f32 v41, v41
    v_exp_f32 v42, v42
    v_exp_f32 v43, v43
    v_smfmac_f32_32x32x32_bf16 v[112:127], v[180:183], v[24:31], v5
    global_load_dwordx4 v[200:203], v1, s[36:37] offset:2048 sc1
    v_exp_f32 v44, v44
    v_exp_f32 v45, v45
    v_exp_f32 v46, v46
    v_exp_f32 v47, v47
    v_mfma_f32_32x32x16_bf16 v[16:31], v[184:187], v[144:147], 0
    ds_read_b64_tr_b16 a[104:105], v13 offset:192
    v_exp_f32 v48, v48
    v_exp_f32 v49, v49
    v_exp_f32 v50, v50
    v_exp_f32 v51, v51
    v_mfma_f32_32x32x16_bf16 v[16:31], v[188:191], v[148:151], v[16:31]
    ds_read_b64_tr_b16 a[106:107], v13 offset:1984
    v_exp_f32 v52, v52
    v_exp_f32 v53, v53
    v_exp_f32 v54, v54
    v_exp_f32 v55, v55
    v_smfmac_f32_32x32x32_bf16 v[64:79], v[176:179], v[32:39], v5
    global_load_dwordx4 v[204:207], v1, s[36:37] offset:3072 sc1
    v_exp_f32 v56, v56
    v_exp_f32 v57, v57
    v_exp_f32 v58, v58
    v_exp_f32 v59, v59
    v_smfmac_f32_32x32x32_bf16 v[64:79], v[180:183], v[40:47], v5
    v_exp_f32 v60, v60
    v_exp_f32 v61, v61
    v_exp_f32 v62, v62
    v_exp_f32 v63, v63
    v_mfma_f32_32x32x16_bf16 v[32:47], v[184:187], v[152:155], 0
    s_add_u32 s3, s29, 5
    s_and_b32 s3, s3, 7
    s_lshl_b32 s3, s3, 13
    ds_read_b64_tr_b16 a[60:61], v13 offset:28672
    v_exp_f32 v16, v16
    v_exp_f32 v17, v17
    v_exp_f32 v18, v18
    v_exp_f32 v19, v19
    v_mfma_f32_32x32x16_bf16 v[32:47], v[188:191], v[156:159], v[32:47]
    s_add_u32 s36, s38, s3
    s_addc_u32 s37, s39, 0
    s_waitcnt vmcnt(16)
    ds_read_b64_tr_b16 a[62:63], v13 offset:30464
    v_exp_f32 v20, v20
    v_exp_f32 v21, v21
    v_exp_f32 v22, v22
    v_exp_f32 v23, v23
    v_smfmac_f32_32x32x32_bf16 v[80:95], v[160:163], v[48:55], v5
    global_load_dwordx4 v[176:179], v1, s[36:37] offset:-4096 sc1
    global_load_dwordx4 v[180:183], v1, s[36:37] offset:-3072 sc1
    v_exp_f32 v24, v24
    v_exp_f32 v25, v25
    v_exp_f32 v26, v26
    v_exp_f32 v27, v27
    v_smfmac_f32_32x32x32_bf16 v[80:95], v[164:167], v[56:63], v5
    global_load_dwordx4 a[232:235], v1, s[36:37] offset:-2048 sc1
    v_exp_f32 v28, v28
    v_exp_f32 v29, v29
    v_exp_f32 v30, v30
    v_exp_f32 v31, v31
    v_mfma_f32_32x32x16_bf16 v[48:63], v[184:187], v[128:131], 0
    ds_read_b64_tr_b16 a[68:69], v13 offset:28704
    v_exp_f32 v32, v32
    v_exp_f32 v33, v33
    v_exp_f32 v34, v34
    v_exp_f32 v35, v35
    v_mfma_f32_32x32x16_bf16 v[48:63], v[188:191], v[132:135], v[48:63]
    ds_read_b64_tr_b16 a[70:71], v13 offset:30496
    v_exp_f32 v36, v36
    v_exp_f32 v37, v37
    v_exp_f32 v38, v38
    v_exp_f32 v39, v39
    v_smfmac_f32_32x32x32_bf16 v[96:111], v[160:163], v[16:23], v5
    global_load_dwordx4 a[236:239], v1, s[36:37] offset:-1024 sc1
    global_load_dwordx4 a[224:227], v1, s[36:37] offset:0 sc1
    v_exp_f32 v40, v40
    v_exp_f32 v41, v41
    v_exp_f32 v42, v42
    v_exp_f32 v43, v43
    v_smfmac_f32_32x32x32_bf16 v[96:111], v[164:167], v[24:31], v5
    global_load_dwordx4 a[228:231], v1, s[36:37] offset:1024 sc1
    s_waitcnt vmcnt(20)
    v_exp_f32 v44, v44
    v_exp_f32 v45, v45
    v_exp_f32 v46, v46
    v_exp_f32 v47, v47
    v_mfma_f32_32x32x16_bf16 v[16:31], v[192:195], v[136:139], 0
    ds_read_b64_tr_b16 a[76:77], v13 offset:28736
    v_exp_f32 v48, v48
    v_exp_f32 v49, v49
    v_exp_f32 v50, v50
    v_exp_f32 v51, v51
    v_mfma_f32_32x32x16_bf16 v[16:31], v[196:199], v[140:143], v[16:31]
    ds_read_b64_tr_b16 a[78:79], v13 offset:30528
    v_exp_f32 v52, v52
    v_exp_f32 v53, v53
    v_exp_f32 v54, v54
    v_exp_f32 v55, v55
    v_smfmac_f32_32x32x32_bf16 v[112:127], v[160:163], v[32:39], v5
    global_load_dwordx4 v[184:187], v1, s[36:37] offset:2048 sc1
    global_load_dwordx4 v[188:191], v1, s[36:37] offset:3072 sc1
    v_exp_f32 v56, v56
    v_exp_f32 v57, v57
    v_exp_f32 v58, v58
    v_exp_f32 v59, v59
    v_smfmac_f32_32x32x32_bf16 v[112:127], v[164:167], v[40:47], v5
    v_exp_f32 v60, v60
    v_exp_f32 v61, v61
    v_exp_f32 v62, v62
    v_exp_f32 v63, v63
    v_mfma_f32_32x32x16_bf16 v[32:47], v[192:195], v[144:147], 0
    s_add_u32 s3, s29, 6
    s_and_b32 s3, s3, 7
    s_lshl_b32 s3, s3, 13
    ds_read_b64_tr_b16 a[84:85], v13 offset:28768
    v_exp_f32 v16, v16
    v_exp_f32 v17, v17
    v_exp_f32 v18, v18
    v_exp_f32 v19, v19
    v_mfma_f32_32x32x16_bf16 v[32:47], v[196:199], v[148:151], v[32:47]
    s_add_u32 s36, s38, s3
    s_addc_u32 s37, s39, 0
    ds_read_b64_tr_b16 a[86:87], v13 offset:30560
    v_exp_f32 v20, v20
    v_exp_f32 v21, v21
    v_exp_f32 v22, v22
    v_exp_f32 v23, v23
    v_smfmac_f32_32x32x32_bf16 v[64:79], v[160:163], v[48:55], v5
    global_load_dwordx4 a[216:219], v1, s[36:37] offset:-4096 sc1
    global_load_dwordx4 a[220:223], v1, s[36:37] offset:-3072 sc1
    v_exp_f32 v24, v24
    v_exp_f32 v25, v25
    v_exp_f32 v26, v26
    v_exp_f32 v27, v27
    v_smfmac_f32_32x32x32_bf16 v[64:79], v[164:167], v[56:63], v5
    global_load_dwordx4 a[208:211], v1, s[36:37] offset:-2048 sc1
    v_exp_f32 v28, v28
    v_exp_f32 v29, v29
    v_exp_f32 v30, v30
    v_exp_f32 v31, v31
    v_mfma_f32_32x32x16_bf16 v[48:63], v[192:195], v[152:155], 0
    ds_read_b64_tr_b16 a[92:93], v13 offset:28800
    v_exp_f32 v32, v32
    v_exp_f32 v33, v33
    v_exp_f32 v34, v34
    v_exp_f32 v35, v35
    v_mfma_f32_32x32x16_bf16 v[48:63], v[196:199], v[156:159], v[48:63]
    s_waitcnt vmcnt(23)
    ds_read_b64_tr_b16 a[94:95], v13 offset:30592
    v_exp_f32 v36, v36
    v_exp_f32 v37, v37
    v_exp_f32 v38, v38
    v_exp_f32 v39, v39
    v_smfmac_f32_32x32x32_bf16 v[80:95], a[248:251], v[16:23], v5
    global_load_dwordx4 a[212:215], v1, s[36:37] offset:-1024 sc1
    global_load_dwordx4 v[160:163], v1, s[36:37] offset:0 sc1
    v_exp_f32 v40, v40
    v_exp_f32 v41, v41
    v_exp_f32 v42, v42
    v_exp_f32 v43, v43
    v_smfmac_f32_32x32x32_bf16 v[80:95], a[252:255], v[24:31], v5
    v_exp_f32 v44, v44
    v_exp_f32 v45, v45
    v_exp_f32 v46, v46
    v_exp_f32 v47, v47
    v_mfma_f32_32x32x16_bf16 v[16:31], v[192:195], v[128:131], 0
    ds_read_b64_tr_b16 a[100:101], v13 offset:28832
    v_exp_f32 v48, v48
    v_exp_f32 v49, v49
    v_exp_f32 v50, v50
    v_exp_f32 v51, v51
    v_mfma_f32_32x32x16_bf16 v[16:31], v[196:199], v[132:135], v[16:31]
    ds_read_b64_tr_b16 a[102:103], v13 offset:30624
    v_exp_f32 v52, v52
    v_exp_f32 v53, v53
    v_exp_f32 v54, v54
    v_exp_f32 v55, v55
    v_smfmac_f32_32x32x32_bf16 v[96:111], a[248:251], v[32:39], v5
    global_load_dwordx4 v[248:251], v12, s[26:27] offset:0 sc1
    global_load_dwordx4 v[252:255], v12, s[26:27] offset:1024 sc1
    v_exp_f32 v56, v56
    v_exp_f32 v57, v57
    v_exp_f32 v58, v58
    v_exp_f32 v59, v59
    v_smfmac_f32_32x32x32_bf16 v[96:111], a[252:255], v[40:47], v5
    global_load_dwordx4 v[164:167], v1, s[36:37] offset:1024 sc1
    s_waitcnt vmcnt(26)
    v_exp_f32 v60, v60
    v_exp_f32 v61, v61
    v_exp_f32 v62, v62
    v_exp_f32 v63, v63
    v_mfma_f32_32x32x16_bf16 v[32:47], v[224:227], v[136:139], 0
    ds_read_b64_tr_b16 a[108:109], v13 offset:28864
    v_exp_f32 v16, v16
    v_exp_f32 v17, v17
    v_exp_f32 v18, v18
    v_exp_f32 v19, v19
    v_mfma_f32_32x32x16_bf16 v[32:47], v[228:231], v[140:143], v[32:47]
    ds_read_b64_tr_b16 a[110:111], v13 offset:30656
    v_add_u32 v13, 57344, v13
    v_exp_f32 v20, v20
    v_exp_f32 v21, v21
    v_exp_f32 v22, v22
    v_exp_f32 v23, v23
    v_smfmac_f32_32x32x32_bf16 v[112:127], a[248:251], v[48:55], v5
    global_load_dwordx4 v[192:195], v1, s[36:37] offset:2048 sc1
    global_load_dwordx4 v[196:199], v1, s[36:37] offset:3072 sc1
    v_exp_f32 v24, v24
    v_exp_f32 v25, v25
    v_exp_f32 v26, v26
    v_exp_f32 v27, v27
    v_smfmac_f32_32x32x32_bf16 v[112:127], a[252:255], v[56:63], v5
    v_exp_f32 v28, v28
    v_exp_f32 v29, v29
    v_exp_f32 v30, v30
    v_exp_f32 v31, v31
    v_mfma_f32_32x32x16_bf16 v[48:63], v[224:227], v[144:147], 0
    s_add_u32 s3, s29, 7
    s_and_b32 s3, s3, 7
    s_lshl_b32 s3, s3, 13
    ds_add_u32 v220, v221 offset:256
    v_exp_f32 v32, v32
    v_exp_f32 v33, v33
    v_exp_f32 v34, v34
    v_exp_f32 v35, v35
    v_mfma_f32_32x32x16_bf16 v[48:63], v[228:231], v[148:151], v[48:63]
    s_add_u32 s36, s38, s3
    s_addc_u32 s37, s39, 0
    v_exp_f32 v36, v36
    v_exp_f32 v37, v37
    v_exp_f32 v38, v38
    v_exp_f32 v39, v39
    v_smfmac_f32_32x32x32_bf16 v[64:79], a[248:251], v[16:23], v5
    global_load_dwordx4 a[200:203], v1, s[36:37] offset:-4096 sc1
    global_load_dwordx4 a[204:207], v1, s[36:37] offset:-3072 sc1
    v_exp_f32 v40, v40
    v_exp_f32 v41, v41
    v_exp_f32 v42, v42
    v_exp_f32 v43, v43
    v_smfmac_f32_32x32x32_bf16 v[64:79], a[252:255], v[24:31], v5
    global_load_dwordx4 a[192:195], v1, s[36:37] offset:-2048 sc1
    v_exp_f32 v44, v44
    v_exp_f32 v45, v45
    v_exp_f32 v46, v46
    v_exp_f32 v47, v47
    v_mfma_f32_32x32x16_bf16 v[16:31], v[224:227], v[152:155], 0
    v_exp_f32 v48, v48
    v_exp_f32 v49, v49
    v_exp_f32 v50, v50
    v_exp_f32 v51, v51
    v_mfma_f32_32x32x16_bf16 v[16:31], v[228:231], v[156:159], v[16:31]
    s_waitcnt vmcnt(29)
    v_exp_f32 v52, v52
    v_exp_f32 v53, v53
    v_exp_f32 v54, v54
    v_exp_f32 v55, v55
    v_smfmac_f32_32x32x32_bf16 v[80:95], v[232:235], v[32:39], v5
    global_load_dwordx4 a[196:199], v1, s[36:37] offset:-1024 sc1
    global_load_dwordx4 a[248:251], v1, s[36:37] offset:0 sc1
    v_exp_f32 v56, v56
    v_exp_f32 v57, v57
    v_exp_f32 v58, v58
    v_exp_f32 v59, v59
    v_smfmac_f32_32x32x32_bf16 v[80:95], v[236:239], v[40:47], v5
    v_exp_f32 v60, v60
    v_exp_f32 v61, v61
    v_exp_f32 v62, v62
    v_exp_f32 v63, v63
    v_mfma_f32_32x32x16_bf16 v[32:47], v[224:227], v[128:131], 0
    v_exp_f32 v16, v16
    v_exp_f32 v17, v17
    v_exp_f32 v18, v18
    v_exp_f32 v19, v19
    v_mfma_f32_32x32x16_bf16 v[32:47], v[228:231], v[132:135], v[32:47]
    v_exp_f32 v20, v20
    v_exp_f32 v21, v21
    v_exp_f32 v22, v22
    v_exp_f32 v23, v23
    v_smfmac_f32_32x32x32_bf16 v[96:111], v[232:235], v[48:55], v5
    global_load_dwordx4 a[252:255], v1, s[36:37] offset:1024 sc1
    global_load_dwordx4 a[184:187], v1, s[36:37] offset:2048 sc1
    v_exp_f32 v24, v24
    v_exp_f32 v25, v25
    v_exp_f32 v26, v26
    v_exp_f32 v27, v27
    v_smfmac_f32_32x32x32_bf16 v[96:111], v[236:239], v[56:63], v5
    global_load_dwordx4 a[188:191], v1, s[36:37] offset:3072 sc1
    s_waitcnt vmcnt(32)
    v_exp_f32 v28, v28
    v_exp_f32 v29, v29
    v_exp_f32 v30, v30
    v_exp_f32 v31, v31
    v_mfma_f32_32x32x16_bf16 v[48:63], a[240:243], v[136:139], 0
    s_waitcnt vmcnt(11)
    v_cmp_ne_u64 vcc, s[68:69], v[248:249]
    v_cmp_ne_u64 s[64:65], s[68:69], v[250:251]
    v_cmp_ne_u64 s[62:63], s[68:69], v[252:253]
    v_cmp_ne_u64 s[42:43], s[68:69], v[254:255]
    v_exp_f32 v32, v32
    v_exp_f32 v33, v33
    v_exp_f32 v34, v34
    v_exp_f32 v35, v35
    v_mfma_f32_32x32x16_bf16 v[48:63], a[244:247], v[140:143], v[48:63]
    s_or_b64 vcc, vcc, s[64:65]
    v_exp_f32 v36, v36
    v_exp_f32 v37, v37
    v_exp_f32 v38, v38
    v_exp_f32 v39, v39
    v_smfmac_f32_32x32x32_bf16 v[112:127], v[232:235], v[16:23], v5
    s_or_b64 s[62:63], s[62:63], s[42:43]
    s_or_b64 vcc, vcc, s[62:63]
    v_exp_f32 v40, v40
    v_exp_f32 v41, v41
    v_exp_f32 v42, v42
    v_exp_f32 v43, v43
    v_smfmac_f32_32x32x32_bf16 v[112:127], v[236:239], v[24:31], v5
    s_cbranch_vccnz L_fp_spin
L_fp_ok:
    v_exp_f32 v44, v44
    v_exp_f32 v45, v45
    v_exp_f32 v46, v46
    v_exp_f32 v47, v47
    v_mfma_f32_32x32x16_bf16 v[16:31], a[240:243], v[144:147], 0
    v_exp_f32 v48, v48
    v_exp_f32 v49, v49
    v_exp_f32 v50, v50
    v_exp_f32 v51, v51
    v_mfma_f32_32x32x16_bf16 v[16:31], a[244:247], v[148:151], v[16:31]
    v_exp_f32 v52, v52
    v_exp_f32 v53, v53
    v_exp_f32 v54, v54
    v_exp_f32 v55, v55
    v_smfmac_f32_32x32x32_bf16 v[64:79], v[232:235], v[32:39], v5
    global_load_dwordx4 a[112:115], v1, s[40:41] offset:0 sc1
    global_load_dwordx4 a[116:119], v1, s[40:41] offset:1024 sc1
    v_exp_f32 v56, v56
    v_exp_f32 v57, v57
    v_exp_f32 v58, v58
    v_exp_f32 v59, v59
    v_smfmac_f32_32x32x32_bf16 v[64:79], v[236:239], v[40:47], v5
    global_load_dwordx4 a[120:123], v1, s[40:41] offset:2048 sc1
    v_exp_f32 v60, v60
    v_exp_f32 v61, v61
    v_exp_f32 v62, v62
    v_exp_f32 v63, v63
    v_mfma_f32_32x32x16_bf16 v[32:47], a[240:243], v[152:155], 0
    ds_read_b32 v14, v220 offset:256
    v_exp_f32 v16, v16
    v_exp_f32 v17, v17
    v_exp_f32 v18, v18
    v_exp_f32 v19, v19
    v_mfma_f32_32x32x16_bf16 v[32:47], a[244:247], v[156:159], v[32:47]
    v_exp_f32 v20, v20
    v_exp_f32 v21, v21
    v_exp_f32 v22, v22
    v_exp_f32 v23, v23
    v_smfmac_f32_32x32x32_bf16 v[80:95], v[240:243], v[48:55], v5
    global_load_dwordx4 a[124:127], v1, s[40:41] offset:3072 sc1
    s_add_u32 s40, s40, 8192
    s_addc_u32 s41, s41, 0
    v_exp_f32 v24, v24
    v_exp_f32 v25, v25
    v_exp_f32 v26, v26
    v_exp_f32 v27, v27
    v_smfmac_f32_32x32x32_bf16 v[80:95], v[244:247], v[56:63], v5
    global_load_dwordx4 a[128:131], v1, s[40:41] offset:-4096 sc1
    v_exp_f32 v28, v28
    v_exp_f32 v29, v29
    v_exp_f32 v30, v30
    v_exp_f32 v31, v31
    v_mfma_f32_32x32x16_bf16 v[48:63], a[240:243], v[128:131], 0
    s_waitcnt lgkmcnt(0)
    v_cmp_ne_u32 vcc, 4, v14
    v_exp_f32 v32, v32
    v_exp_f32 v33, v33
    v_exp_f32 v34, v34
    v_exp_f32 v35, v35
    v_mfma_f32_32x32x16_bf16 v[48:63], a[244:247], v[132:135], v[48:63]
    s_cbranch_vccnz L_arr_spin
L_arr_ok:
    v_exp_f32 v36, v36
    v_exp_f32 v37, v37
    v_exp_f32 v38, v38
    v_exp_f32 v39, v39
    v_smfmac_f32_32x32x32_bf16 v[96:111], v[240:243], v[16:23], v5
    global_load_dwordx4 a[132:135], v1, s[40:41] offset:-3072 sc1
    global_load_dwordx4 a[136:139], v1, s[40:41] offset:-2048 sc1
    v_exp_f32 v40, v40
    v_exp_f32 v41, v41
    v_exp_f32 v42, v42
    v_exp_f32 v43, v43
    v_smfmac_f32_32x32x32_bf16 v[96:111], v[244:247], v[24:31], v5
    global_load_dwordx4 a[140:143], v1, s[40:41] offset:-1024 sc1
    v_exp_f32 v44, v44
    v_exp_f32 v45, v45
    v_exp_f32 v46, v46
    v_exp_f32 v47, v47
    v_mfma_f32_32x32x16_bf16 v[16:31], v[168:171], v[136:139], 0
    v_exp_f32 v48, v48
    v_exp_f32 v49, v49
    v_exp_f32 v50, v50
    v_exp_f32 v51, v51
    v_mfma_f32_32x32x16_bf16 v[16:31], v[172:175], v[140:143], v[16:31]
    v_exp_f32 v52, v52
    v_exp_f32 v53, v53
    v_exp_f32 v54, v54
    v_exp_f32 v55, v55
    v_smfmac_f32_32x32x32_bf16 v[112:127], v[240:243], v[32:39], v5
    global_load_dwordx4 a[144:147], v1, s[40:41] offset:0 sc1
    global_load_dwordx4 a[148:151], v1, s[40:41] offset:1024 sc1
    s_add_u32 s40, s40, 8192
    s_addc_u32 s41, s41, 0
    v_exp_f32 v56, v56
    v_exp_f32 v57, v57
    v_exp_f32 v58, v58
    v_exp_f32 v59, v59
    v_smfmac_f32_32x32x32_bf16 v[112:127], v[244:247], v[40:47], v5
    global_load_dwordx4 a[152:155], v1, s[40:41] offset:-2048 sc1
    v_exp_f32 v60, v60
    v_exp_f32 v61, v61
    v_exp_f32 v62, v62
    v_exp_f32 v63, v63
    v_mfma_f32_32x32x16_bf16 v[32:47], v[168:171], v[144:147], 0
    v_exp_f32 v16, v16
    v_exp_f32 v17, v17
    v_exp_f32 v18, v18
    v_exp_f32 v19, v19
    v_mfma_f32_32x32x16_bf16 v[32:47], v[172:175], v[148:151], v[32:47]
    v_exp_f32 v20, v20
    v_exp_f32 v21, v21
    v_exp_f32 v22, v22
    v_exp_f32 v23, v23
    v_smfmac_f32_32x32x32_bf16 v[64:79], v[240:243], v[48:55], v5
    global_load_dwordx4 a[156:159], v1, s[40:41] offset:-1024 sc1
    global_load_dwordx4 a[160:163], v1, s[40:41] offset:0 sc1
    v_exp_f32 v24, v24
    v_exp_f32 v25, v25
    v_exp_f32 v26, v26
    v_exp_f32 v27, v27
    v_smfmac_f32_32x32x32_bf16 v[64:79], v[244:247], v[56:63], v5
    v_exp_f32 v28, v28
    v_exp_f32 v29, v29
    v_exp_f32 v30, v30
    v_exp_f32 v31, v31
    v_mfma_f32_32x32x16_bf16 v[48:63], v[168:171], v[152:155], 0
    v_exp_f32 v32, v32
    v_exp_f32 v33, v33
    v_exp_f32 v34, v34
    v_exp_f32 v35, v35
    v_mfma_f32_32x32x16_bf16 v[48:63], v[172:175], v[156:159], v[48:63]
    v_exp_f32 v36, v36
    v_exp_f32 v37, v37
    v_exp_f32 v38, v38
    v_exp_f32 v39, v39
    v_smfmac_f32_32x32x32_bf16 v[80:95], v[200:203], v[16:23], v5
    global_load_dwordx4 a[164:167], v1, s[40:41] offset:1024 sc1
    global_load_dwordx4 a[168:171], v1, s[40:41] offset:2048 sc1
    v_exp_f32 v40, v40
    v_exp_f32 v41, v41
    v_exp_f32 v42, v42
    v_exp_f32 v43, v43
    v_smfmac_f32_32x32x32_bf16 v[80:95], v[204:207], v[24:31], v5
    global_load_dwordx4 a[172:175], v1, s[40:41] offset:3072 sc1
    v_exp_f32 v44, v44
    v_exp_f32 v45, v45
    v_exp_f32 v46, v46
    v_exp_f32 v47, v47
    v_mfma_f32_32x32x16_bf16 v[16:31], v[168:171], v[128:131], 0
    v_exp_f32 v48, v48
    v_exp_f32 v49, v49
    v_exp_f32 v50, v50
    v_exp_f32 v51, v51
    v_mfma_f32_32x32x16_bf16 v[16:31], v[172:175], v[132:135], v[16:31]
    s_add_u32 s40, s40, 8192
    s_addc_u32 s41, s41, 0
    v_exp_f32 v52, v52
    v_exp_f32 v53, v53
    v_exp_f32 v54, v54
    v_exp_f32 v55, v55
    v_smfmac_f32_32x32x32_bf16 v[96:111], v[200:203], v[32:39], v5
    global_load_dwordx4 a[176:179], v1, s[40:41] offset:-4096 sc1
    global_load_dwordx4 a[180:183], v1, s[40:41] offset:-3072 sc1
    v_exp_f32 v56, v56
    v_exp_f32 v57, v57
    v_exp_f32 v58, v58
    v_exp_f32 v59, v59
    v_smfmac_f32_32x32x32_bf16 v[96:111], v[204:207], v[40:47], v5
    v_exp_f32 v60, v60
    v_exp_f32 v61, v61
    v_exp_f32 v62, v62
    v_exp_f32 v63, v63
    v_mfma_f32_32x32x16_bf16 v[32:47], v[176:179], v[136:139], 0
    v_exp_f32 v16, v16
    v_exp_f32 v17, v17
    v_exp_f32 v18, v18
    v_exp_f32 v19, v19
    v_mfma_f32_32x32x16_bf16 v[32:47], v[180:183], v[140:143], v[32:47]
    v_exp_f32 v20, v20
    v_exp_f32 v21, v21
    v_exp_f32 v22, v22
    v_exp_f32 v23, v23
    v_smfmac_f32_32x32x32_bf16 v[112:127], v[200:203], v[48:55], v5
    global_load_dwordx4 v[224:227], v1, s[40:41] offset:-2048 sc1
    global_load_dwordx4 v[228:231], v1, s[40:41] offset:-1024 sc1
    s_add_u32 s40, s40, 8192
    s_addc_u32 s41, s41, 0
    v_exp_f32 v24, v24
    v_exp_f32 v25, v25
    v_exp_f32 v26, v26
    v_exp_f32 v27, v27
    v_smfmac_f32_32x32x32_bf16 v[112:127], v[204:207], v[56:63], v5
    global_load_dwordx4 v[248:251], v1, s[40:41] offset:-4096 sc1
    v_exp_f32 v28, v28
    v_exp_f32 v29, v29
    v_exp_f32 v30, v30
    v_exp_f32 v31, v31
    v_mfma_f32_32x32x16_bf16 v[48:63], v[176:179], v[144:147], 0
    v_exp_f32 v32, v32
    v_exp_f32 v33, v33
    v_exp_f32 v34, v34
    v_exp_f32 v35, v35
    v_mfma_f32_32x32x16_bf16 v[48:63], v[180:183], v[148:151], v[48:63]
    v_exp_f32 v36, v36
    v_exp_f32 v37, v37
    v_exp_f32 v38, v38
    v_exp_f32 v39, v39
    v_smfmac_f32_32x32x32_bf16 v[64:79], v[200:203], v[16:23], v5
    global_load_dwordx4 v[252:255], v1, s[40:41] offset:-3072 sc1
    global_load_dwordx4 v[232:235], v1, s[40:41] offset:-2048 sc1
    v_exp_f32 v40, v40
    v_exp_f32 v41, v41
    v_exp_f32 v42, v42
    v_exp_f32 v43, v43
    v_smfmac_f32_32x32x32_bf16 v[64:79], v[204:207], v[24:31], v5
    v_exp_f32 v44, v44
    v_exp_f32 v45, v45
    v_exp_f32 v46, v46
    v_exp_f32 v47, v47
    v_mfma_f32_32x32x16_bf16 v[16:31], v[176:179], v[152:155], 0
    v_exp_f32 v48, v48
    v_exp_f32 v49, v49
    v_exp_f32 v50, v50
    v_exp_f32 v51, v51
    v_mfma_f32_32x32x16_bf16 v[16:31], v[180:183], v[156:159], v[16:31]
    v_exp_f32 v52, v52
    v_exp_f32 v53, v53
    v_exp_f32 v54, v54
    v_exp_f32 v55, v55
    v_smfmac_f32_32x32x32_bf16 v[80:95], a[232:235], v[32:39], v5
    global_load_dwordx4 v[236:239], v1, s[40:41] offset:-1024 sc1
    global_load_dwordx4 a[240:243], v1, s[40:41] offset:0 sc1
    v_exp_f32 v56, v56
    v_exp_f32 v57, v57
    v_exp_f32 v58, v58
    v_exp_f32 v59, v59
    v_smfmac_f32_32x32x32_bf16 v[80:95], a[236:239], v[40:47], v5
    global_load_dwordx4 a[244:247], v1, s[40:41] offset:1024 sc1
    v_exp_f32 v60, v60
    v_exp_f32 v61, v61
    v_exp_f32 v62, v62
    v_exp_f32 v63, v63
    v_mfma_f32_32x32x16_bf16 v[32:47], v[176:179], v[128:131], 0
    v_exp_f32 v16, v16
    v_exp_f32 v17, v17
    v_exp_f32 v18, v18
    v_exp_f32 v19, v19
    v_mfma_f32_32x32x16_bf16 v[32:47], v[180:183], v[132:135], v[32:47]
    v_exp_f32 v20, v20
    v_exp_f32 v21, v21
    v_exp_f32 v22, v22
    v_exp_f32 v23, v23
    v_smfmac_f32_32x32x32_bf16 v[96:111], a[232:235], v[48:55], v5
    global_load_dwordx4 v[240:243], v1, s[40:41] offset:2048 sc1
    global_load_dwordx4 v[244:247], v1, s[40:41] offset:3072 sc1
    v_exp_f32 v24, v24
    v_exp_f32 v25, v25
    v_exp_f32 v26, v26
    v_exp_f32 v27, v27
    v_smfmac_f32_32x32x32_bf16 v[96:111], a[236:239], v[56:63], v5
    v_exp_f32 v28, v28
    v_exp_f32 v29, v29
    v_exp_f32 v30, v30
    v_exp_f32 v31, v31
    v_mfma_f32_32x32x16_bf16 v[48:63], a[224:227], v[136:139], 0
    v_exp_f32 v32, v32
    v_exp_f32 v33, v33
    v_exp_f32 v34, v34
    v_exp_f32 v35, v35
    v_mfma_f32_32x32x16_bf16 v[48:63], a[228:231], v[140:143], v[48:63]
    s_add_u32 s40, s40, 8192
    s_addc_u32 s41, s41, 0
    v_exp_f32 v36, v36
    v_exp_f32 v37, v37
    v_exp_f32 v38, v38
    v_exp_f32 v39, v39
    v_smfmac_f32_32x32x32_bf16 v[112:127], a[232:235], v[16:23], v5
    global_load_dwordx4 v[168:171], v1, s[40:41] offset:-4096 sc1
    global_load_dwordx4 v[172:175], v1, s[40:41] offset:-3072 sc1
    v_exp_f32 v40, v40
    v_exp_f32 v41, v41
    v_exp_f32 v42, v42
    v_exp_f32 v43, v43
    v_smfmac_f32_32x32x32_bf16 v[112:127], a[236:239], v[24:31], v5
    global_load_dwordx4 v[200:203], v1, s[40:41] offset:2048 sc1
    v_exp_f32 v44, v44
    v_exp_f32 v45, v45
    v_exp_f32 v46, v46
    v_exp_f32 v47, v47
    v_mfma_f32_32x32x16_bf16 v[16:31], a[224:227], v[144:147], 0
    v_exp_f32 v48, v48
    v_exp_f32 v49, v49
    v_exp_f32 v50, v50
    v_exp_f32 v51, v51
    v_mfma_f32_32x32x16_bf16 v[16:31], a[228:231], v[148:151], v[16:31]
    v_exp_f32 v52, v52
    v_exp_f32 v53, v53
    v_exp_f32 v54, v54
    v_exp_f32 v55, v55
    v_smfmac_f32_32x32x32_bf16 v[64:79], a[232:235], v[32:39], v5
    global_load_dwordx4 v[204:207], v1, s[40:41] offset:3072 sc1
    v_exp_f32 v56, v56
    v_exp_f32 v57, v57
    v_exp_f32 v58, v58
    v_exp_f32 v59, v59
    v_smfmac_f32_32x32x32_bf16 v[64:79], a[236:239], v[40:47], v5
    v_exp_f32 v60, v60
    v_exp_f32 v61, v61
    v_exp_f32 v62, v62
    v_exp_f32 v63, v63
    v_mfma_f32_32x32x16_bf16 v[32:47], a[224:227], v[152:155], 0
    v_exp_f32 v16, v16
    v_exp_f32 v17, v17
    v_exp_f32 v18, v18
    v_exp_f32 v19, v19
    v_mfma_f32_32x32x16_bf16 v[32:47], a[228:231], v[156:159], v[32:47]
    s_add_u32 s40, s40, 8192
    s_addc_u32 s41, s41, 0
    v_exp_f32 v20, v20
    v_exp_f32 v21, v21
    v_exp_f32 v22, v22
    v_exp_f32 v23, v23
    v_smfmac_f32_32x32x32_bf16 v[80:95], v[184:187], v[48:55], v5
    global_load_dwordx4 v[176:179], v1, s[40:41] offset:-4096 sc1
    global_load_dwordx4 v[180:183], v1, s[40:41] offset:-3072 sc1
    v_exp_f32 v24, v24
    v_exp_f32 v25, v25
    v_exp_f32 v26, v26
    v_exp_f32 v27, v27
    v_smfmac_f32_32x32x32_bf16 v[80:95], v[188:191], v[56:63], v5
    global_load_dwordx4 a[232:235], v1, s[40:41] offset:-2048 sc1
    v_exp_f32 v28, v28
    v_exp_f32 v29, v29
    v_exp_f32 v30, v30
    v_exp_f32 v31, v31
    v_mfma_f32_32x32x16_bf16 v[48:63], a[224:227], v[128:131], 0
    v_exp_f32 v32, v32
    v_exp_f32 v33, v33
    v_exp_f32 v34, v34
    v_exp_f32 v35, v35
    v_mfma_f32_32x32x16_bf16 v[48:63], a[228:231], v[132:135], v[48:63]
    v_exp_f32 v36, v36
    v_exp_f32 v37, v37
    v_exp_f32 v38, v38
    v_exp_f32 v39, v39
    v_smfmac_f32_32x32x32_bf16 v[96:111], v[184:187], v[16:23], v5
    global_load_dwordx4 a[236:239], v1, s[40:41] offset:-1024 sc1
    s_add_u32 m0, s58, 0
    v_exp_f32 v40, v40
    v_exp_f32 v41, v41
    v_exp_f32 v42, v42
    v_exp_f32 v43, v43
    v_smfmac_f32_32x32x32_bf16 v[96:111], v[188:191], v[24:31], v5
    buffer_load_dwordx4 v1, s[44:47], m0 offen offset:0 sc1 lds
    v_exp_f32 v44, v44
    v_exp_f32 v45, v45
    v_exp_f32 v46, v46
    v_exp_f32 v47, v47
    v_mfma_f32_32x32x16_bf16 v[16:31], a[216:219], v[136:139], 0
    v_exp_f32 v48, v48
    v_exp_f32 v49, v49
    v_exp_f32 v50, v50
    v_exp_f32 v51, v51
    v_mfma_f32_32x32x16_bf16 v[16:31], a[220:223], v[140:143], v[16:31]
    v_exp_f32 v52, v52
    v_exp_f32 v53, v53
    v_exp_f32 v54, v54
    v_exp_f32 v55, v55
    v_smfmac_f32_32x32x32_bf16 v[112:127], v[184:187], v[32:39], v5
    global_load_dwordx4 a[224:227], v1, s[40:41] offset:0 sc1
    global_load_dwordx4 a[228:231], v1, s[40:41] offset:1024 sc1
    v_exp_f32 v56, v56
    v_exp_f32 v57, v57
    v_exp_f32 v58, v58
    v_exp_f32 v59, v59
    v_smfmac_f32_32x32x32_bf16 v[112:127], v[188:191], v[40:47], v5
    buffer_load_dwordx4 v1, s[44:47], m0 offen offset:1024 sc1 lds
    v_exp_f32 v60, v60
    v_exp_f32 v61, v61
    v_exp_f32 v62, v62
    v_exp_f32 v63, v63
    v_mfma_f32_32x32x16_bf16 v[32:47], a[216:219], v[144:147], 0
    v_exp_f32 v16, v16
    v_exp_f32 v17, v17
    v_exp_f32 v18, v18
    v_exp_f32 v19, v19
    v_mfma_f32_32x32x16_bf16 v[32:47], a[220:223], v[148:151], v[32:47]
    v_exp_f32 v20, v20
    v_exp_f32 v21, v21
    v_exp_f32 v22, v22
    v_exp_f32 v23, v23
    v_smfmac_f32_32x32x32_bf16 v[64:79], v[184:187], v[48:55], v5
    buffer_load_dwordx4 v1, s[44:47], m0 offen offset:2048 sc1 lds
    s_add_u32 m0, s58, 3072
    v_exp_f32 v24, v24
    v_exp_f32 v25, v25
    v_exp_f32 v26, v26
    v_exp_f32 v27, v27
    v_smfmac_f32_32x32x32_bf16 v[64:79], v[188:191], v[56:63], v5
    buffer_load_dwordx4 v1, s[44:47], m0 offen offset:0 sc1 lds
    v_exp_f32 v28, v28
    v_exp_f32 v29, v29
    v_exp_f32 v30, v30
    v_exp_f32 v31, v31
    v_mfma_f32_32x32x16_bf16 v[48:63], a[216:219], v[152:155], 0
    v_exp_f32 v32, v32
    v_exp_f32 v33, v33
    v_exp_f32 v34, v34
    v_exp_f32 v35, v35
    v_mfma_f32_32x32x16_bf16 v[48:63], a[220:223], v[156:159], v[48:63]
    v_exp_f32 v36, v36
    v_exp_f32 v37, v37
    v_exp_f32 v38, v38
    v_exp_f32 v39, v39
    v_smfmac_f32_32x32x32_bf16 v[80:95], a[208:211], v[16:23], v5
    global_load_dwordx4 v[184:187], v1, s[40:41] offset:2048 sc1
    global_load_dwordx4 v[188:191], v1, s[40:41] offset:3072 sc1
    v_exp_f32 v40, v40
    v_exp_f32 v41, v41
    v_exp_f32 v42, v42
    v_exp_f32 v43, v43
    v_smfmac_f32_32x32x32_bf16 v[80:95], a[212:215], v[24:31], v5
L_pad2:
    s_cbranch_execz L_back0
    buffer_load_dwordx4 v1, s[44:47], m0 offen offset:1024 sc1 lds
    v_exp_f32 v44, v44
    v_exp_f32 v45, v45
    v_exp_f32 v46, v46
    v_exp_f32 v47, v47
    v_mfma_f32_32x32x16_bf16 v[16:31], a[216:219], v[128:131], 0
    v_exp_f32 v48, v48
    v_exp_f32 v49, v49
    v_exp_f32 v50, v50
    v_exp_f32 v51, v51
    v_mfma_f32_32x32x16_bf16 v[16:31], a[220:223], v[132:135], v[16:31]
    v_exp_f32 v52, v52
    v_exp_f32 v53, v53
    v_exp_f32 v54, v54
    v_exp_f32 v55, v55
    v_smfmac_f32_32x32x32_bf16 v[96:111], a[208:211], v[32:39], v5
    buffer_load_dwordx4 v1, s[44:47], m0 offen offset:2048 sc1 lds
    buffer_load_dwordx4 v1, s[44:47], m0 offen offset:3072 sc1 lds
    s_add_u32 m0, s58, 28672
    v_exp_f32 v56, v56
    v_exp_f32 v57, v57
    v_exp_f32 v58, v58
    v_exp_f32 v59, v59
    v_smfmac_f32_32x32x32_bf16 v[96:111], a[212:215], v[40:47], v5
    buffer_load_dwordx4 v1, s[44:47], m0 offen offset:0 sc1 lds
    s_waitcnt vmcnt(58)
    v_exp_f32 v60, v60
    v_exp_f32 v61, v61
    v_exp_f32 v62, v62
    v_exp_f32 v63, v63
    v_mfma_f32_32x32x16_bf16 v[32:47], v[160:163], v[136:139], 0
    v_exp_f32 v16, v16
    v_exp_f32 v17, v17
    v_exp_f32 v18, v18
    v_exp_f32 v19, v19
    v_mfma_f32_32x32x16_bf16 v[32:47], v[164:167], v[140:143], v[32:47]
    s_add_u32 s40, s40, 8192
    s_addc_u32 s41, s41, 0
    v_exp_f32 v20, v20
    v_exp_f32 v21, v21
    v_exp_f32 v22, v22
    v_exp_f32 v23, v23
    v_smfmac_f32_32x32x32_bf16 v[112:127], a[208:211], v[48:55], v5
    global_load_dwordx4 a[216:219], v1, s[40:41] offset:0 sc1
    global_load_dwordx4 a[220:223], v1, s[40:41] offset:1024 sc1
    v_exp_f32 v24, v24
    v_exp_f32 v25, v25
    v_exp_f32 v26, v26
    v_exp_f32 v27, v27
    v_smfmac_f32_32x32x32_bf16 v[112:127], a[212:215], v[56:63], v5
    v_exp_f32 v28, v28
    v_exp_f32 v29, v29
    v_exp_f32 v30, v30
    v_exp_f32 v31, v31
    v_mfma_f32_32x32x16_bf16 v[48:63], v[160:163], v[144:147], 0
    v_exp_f32 v32, v32
    v_exp_f32 v33, v33
    v_exp_f32 v34, v34
    v_exp_f32 v35, v35
    v_mfma_f32_32x32x16_bf16 v[48:63], v[164:167], v[148:151], v[48:63]
    v_exp_f32 v36, v36
    v_exp_f32 v37, v37
    v_exp_f32 v38, v38
    v_exp_f32 v39, v39
    v_smfmac_f32_32x32x32_bf16 v[64:79], a[208:211], v[16:23], v5
    buffer_load_dwordx4 v1, s[44:47], m0 offen offset:1024 sc1 lds
    buffer_load_dwordx4 v1, s[44:47], m0 offen offset:2048 sc1 lds
    s_add_u32 m0, s58, 31744
    v_exp_f32 v40, v40
    v_exp_f32 v41, v41
    v_exp_f32 v42, v42
    v_exp_f32 v43, v43
    v_smfmac_f32_32x32x32_bf16 v[64:79], a[212:215], v[24:31], v5
    buffer_load_dwordx4 v1, s[44:47], m0 offen offset:0 sc1 lds
    v_exp_f32 v44, v44
    v_exp_f32 v45, v45
    v_exp_f32 v46, v46
    v_exp_f32 v47, v47
    v_mfma_f32_32x32x16_bf16 v[16:31], v[160:163], v[152:155], 0
    v_exp_f32 v48, v48
    v_exp_f32 v49, v49
    v_exp_f32 v50, v50
    v_exp_f32 v51, v51
    v_mfma_f32_32x32x16_bf16 v[16:31], v[164:167], v[156:159], v[16:31]
    s_waitcnt vmcnt(61)
    v_exp_f32 v52, v52
    v_exp_f32 v53, v53
    v_exp_f32 v54, v54
    v_exp_f32 v55, v55
    v_smfmac_f32_32x32x32_bf16 v[80:95], v[192:195], v[32:39], v5
    global_load_dwordx4 a[208:211], v1, s[40:41] offset:2048 sc1
    global_load_dwordx4 a[212:215], v1, s[40:41] offset:3072 sc1
    v_exp_f32 v56, v56
    v_exp_f32 v57, v57
    v_exp_f32 v58, v58
    v_exp_f32 v59, v59
    v_smfmac_f32_32x32x32_bf16 v[80:95], v[196:199], v[40:47], v5
    s_waitcnt vmcnt(61)
    v_exp_f32 v60, v60
    v_exp_f32 v61, v61
    v_exp_f32 v62, v62
    v_exp_f32 v63, v63
    v_mfma_f32_32x32x16_bf16 v[32:47], a[200:203], v[136:139], 0
    v_exp_f32 v16, v16
    v_exp_f32 v17, v17
    v_exp_f32 v18, v18
    v_exp_f32 v19, v19
    v_mfma_f32_32x32x16_bf16 v[32:47], a[204:207], v[140:143], v[32:47]
    v_exp_f32 v20, v20
    v_exp_f32 v21, v21
    v_exp_f32 v22, v22
    v_exp_f32 v23, v23
    v_smfmac_f32_32x32x32_bf16 v[96:111], v[192:195], v[48:55], v5
    buffer_load_dwordx4 v1, s[44:47], m0 offen offset:1024 sc1 lds
    buffer_load_dwordx4 v1, s[44:47], m0 offen offset:2048 sc1 lds
    v_exp_f32 v24, v24
    v_exp_f32 v25, v25
    v_exp_f32 v26, v26
    v_exp_f32 v27, v27
    v_smfmac_f32_32x32x32_bf16 v[96:111], v[196:199], v[56:63], v5
    s_waitcnt vmcnt(30)
    buffer_load_dwordx4 v1, s[44:47], m0 offen offset:3072 sc1 lds
    v_exp_f32 v28, v28
    v_exp_f32 v29, v29
    v_exp_f32 v30, v30
    v_exp_f32 v31, v31
    v_mfma_f32_32x32x16_bf16 v[48:63], a[248:251], v[136:139], 0
    v_exp_f32 v32, v32
    v_exp_f32 v33, v33
    v_exp_f32 v34, v34
    v_exp_f32 v35, v35
    v_mfma_f32_32x32x16_bf16 v[48:63], a[252:255], v[140:143], v[48:63]
    s_add_u32 m0, s58, 57344
    v_exp_f32 v36, v36
    v_exp_f32 v37, v37
    v_exp_f32 v38, v38
    v_exp_f32 v39, v39
    v_smfmac_f32_32x32x32_bf16 v[112:127], v[192:195], v[16:23], v5
    buffer_load_dwordx4 v1, s[44:47], m0 offen offset:0 sc1 lds
    buffer_load_dwordx4 v1, s[44:47], m0 offen offset:1024 sc1 lds
    v_exp_f32 v40, v40
    v_exp_f32 v41, v41
    v_exp_f32 v42, v42
    v_exp_f32 v43, v43
    v_smfmac_f32_32x32x32_bf16 v[112:127], v[196:199], v[24:31], v5
    v_exp_f32 v44, v44
    v_exp_f32 v45, v45
    v_exp_f32 v46, v46
    v_exp_f32 v47, v47
    v_mfma_f32_32x32x16_bf16 v[16:31], a[200:203], v[144:147], 0
    v_exp_f32 v48, v48
    v_exp_f32 v49, v49
    v_exp_f32 v50, v50
    v_exp_f32 v51, v51
    v_mfma_f32_32x32x16_bf16 v[16:31], a[204:207], v[148:151], v[16:31]
    s_add_u32 s40, s40, 8192
    s_addc_u32 s41, s41, 0
    v_exp_f32 v52, v52
    v_exp_f32 v53, v53
    v_exp_f32 v54, v54
    v_exp_f32 v55, v55
    v_smfmac_f32_32x32x32_bf16 v[80:95], a[192:195], v[32:39], v5
    global_load_dwordx4 v[136:139], v1, s[40:41] offset:-4096 sc1
    global_load_dwordx4 v[140:143], v1, s[40:41] offset:-3072 sc1
    v_exp_f32 v56, v56
    v_exp_f32 v57, v57
    v_exp_f32 v58, v58
    v_exp_f32 v59, v59
    v_smfmac_f32_32x32x32_bf16 v[80:95], a[196:199], v[40:47], v5
    buffer_load_dwordx4 v1, s[44:47], m0 offen offset:2048 sc1 lds
    v_exp_f32 v60, v60
    v_exp_f32 v61, v61
    v_exp_f32 v62, v62
    v_exp_f32 v63, v63
    v_mfma_f32_32x32x16_bf16 v[32:47], a[248:251], v[144:147], 0
    v_exp_f32 v16, v16
    v_exp_f32 v17, v17
    v_exp_f32 v18, v18
    v_exp_f32 v19, v19
    v_mfma_f32_32x32x16_bf16 v[32:47], a[252:255], v[148:151], v[32:47]
    s_add_u32 m0, s58, 60416
    v_exp_f32 v20, v20
    v_exp_f32 v21, v21
    v_exp_f32 v22, v22
    v_exp_f32 v23, v23
    v_smfmac_f32_32x32x32_bf16 v[80:95], a[184:187], v[48:55], v5
    buffer_load_dwordx4 v1, s[44:47], m0 offen offset:0 sc1 lds
    buffer_load_dwordx4 v1, s[44:47], m0 offen offset:1024 sc1 lds
    v_exp_f32 v24, v24
    v_exp_f32 v25, v25
    v_exp_f32 v26, v26
    v_exp_f32 v27, v27
    v_smfmac_f32_32x32x32_bf16 v[80:95], a[188:191], v[56:63], v5
    v_exp_f32 v28, v28
    v_exp_f32 v29, v29
    v_exp_f32 v30, v30
    v_exp_f32 v31, v31
    v_mfma_f32_32x32x16_bf16 v[48:63], a[200:203], v[152:155], 0
    v_exp_f32 v32, v32
    v_exp_f32 v33, v33
    v_exp_f32 v34, v34
    v_exp_f32 v35, v35
    v_mfma_f32_32x32x16_bf16 v[48:63], a[204:207], v[156:159], v[48:63]
    v_exp_f32 v36, v36
    v_exp_f32 v37, v37
    v_exp_f32 v38, v38
    v_exp_f32 v39, v39
    v_smfmac_f32_32x32x32_bf16 v[96:111], a[192:195], v[16:23], v5
    ds_write_b128 v6, v[80:83] offset:0
    v_exp_f32 v40, v40
    v_exp_f32 v41, v41
    v_exp_f32 v42, v42
    v_exp_f32 v43, v43
    v_smfmac_f32_32x32x32_bf16 v[96:111], a[196:199], v[24:31], v5
    global_load_dwordx4 v[144:147], v1, s[40:41] offset:-2048 sc1
    global_load_dwordx4 v[148:151], v1, s[40:41] offset:-1024 sc1
    v_exp_f32 v44, v44
    v_exp_f32 v45, v45
    v_exp_f32 v46, v46
    v_exp_f32 v47, v47
    v_mfma_f32_32x32x16_bf16 v[16:31], a[248:251], v[152:155], 0
    ds_write_b128 v6, v[84:87] offset:1024
    v_exp_f32 v48, v48
    v_exp_f32 v49, v49
    v_exp_f32 v50, v50
    v_exp_f32 v51, v51
    v_mfma_f32_32x32x16_bf16 v[16:31], a[252:255], v[156:159], v[16:31]
    v_exp_f32 v52, v52
    v_exp_f32 v53, v53
    v_exp_f32 v54, v54
    v_exp_f32 v55, v55
    v_smfmac_f32_32x32x32_bf16 v[96:111], a[184:187], v[32:39], v5
    ds_write_b128 v6, v[88:91] offset:2048
    v_exp_f32 v56, v56
    v_exp_f32 v57, v57
    v_exp_f32 v58, v58
    v_exp_f32 v59, v59
    v_smfmac_f32_32x32x32_bf16 v[96:111], a[188:191], v[40:47], v5
    buffer_load_dwordx4 v1, s[44:47], m0 offen offset:2048 sc1 lds
    buffer_load_dwordx4 v1, s[44:47], m0 offen offset:3072 sc1 lds
    v_exp_f32 v60, v60
    v_exp_f32 v61, v61
    v_exp_f32 v62, v62
    v_exp_f32 v63, v63
    v_mfma_f32_32x32x16_bf16 v[32:47], v[160:163], v[128:131], 0
    ds_write_b128 v6, v[92:95] offset:3072
    v_exp_f32 v16, v16
    v_exp_f32 v17, v17
    v_exp_f32 v18, v18
    v_exp_f32 v19, v19
    v_mfma_f32_32x32x16_bf16 v[32:47], v[164:167], v[132:135], v[32:47]
    v_exp_f32 v20, v20
    v_exp_f32 v21, v21
    v_exp_f32 v22, v22
    v_exp_f32 v23, v23
    v_smfmac_f32_32x32x32_bf16 v[112:127], a[192:195], v[48:55], v5
    ds_write_b128 v7, v[96:99] offset:0
    v_exp_f32 v24, v24
    v_exp_f32 v25, v25
    v_exp_f32 v26, v26
    v_exp_f32 v27, v27
    v_smfmac_f32_32x32x32_bf16 v[112:127], a[196:199], v[56:63], v5
    global_load_dwordx4 v[152:155], v1, s[40:41] offset:0 sc1
    global_load_dwordx4 v[156:159], v1, s[40:41] offset:1024 sc1
    v_exp_f32 v28, v28
    v_exp_f32 v29, v29
    v_exp_f32 v30, v30
    v_exp_f32 v31, v31
    v_mfma_f32_32x32x16_bf16 v[48:63], a[200:203], v[128:131], 0
    ds_write_b128 v7, v[100:103] offset:1024
    v_exp_f32 v32, v32
    v_exp_f32 v33, v33
    v_exp_f32 v34, v34
    v_exp_f32 v35, v35
    v_mfma_f32_32x32x16_bf16 v[48:63], a[204:207], v[132:135], v[48:63]
    s_add_u32 s40, s40, 8192
    s_addc_u32 s41, s41, 0
    v_exp_f32 v36, v36
    v_exp_f32 v37, v37
    v_exp_f32 v38, v38
    v_exp_f32 v39, v39
    v_smfmac_f32_32x32x32_bf16 v[112:127], a[184:187], v[16:23], v5
    ds_write_b128 v7, v[104:107] offset:2048
    v_exp_f32 v40, v40
    v_exp_f32 v41, v41
    v_exp_f32 v42, v42
    v_exp_f32 v43, v43
    v_smfmac_f32_32x32x32_bf16 v[112:127], a[188:191], v[24:31], v5
    global_load_dwordx4 v[160:163], v1, s[40:41] offset:-2048 sc1
    global_load_dwordx4 v[164:167], v1, s[40:41] offset:-1024 sc1
    v_exp_f32 v44, v44
    v_exp_f32 v45, v45
    v_exp_f32 v46, v46
    v_exp_f32 v47, v47
    v_mfma_f32_32x32x16_bf16 v[16:31], a[248:251], v[128:131], 0
    ds_write_b128 v7, v[108:111] offset:3072
    v_exp_f32 v48, v48
    v_exp_f32 v49, v49
    v_exp_f32 v50, v50
    v_exp_f32 v51, v51
    v_mfma_f32_32x32x16_bf16 v[16:31], a[252:255], v[132:135], v[16:31]
    v_exp_f32 v52, v52
    v_exp_f32 v53, v53
    v_exp_f32 v54, v54
    v_exp_f32 v55, v55
    v_smfmac_f32_32x32x32_bf16 v[64:79], v[192:195], v[32:39], v5
    ds_write_b128 v8, v[112:115] offset:0
    v_exp_f32 v56, v56
    v_exp_f32 v57, v57
    v_exp_f32 v58, v58
    v_exp_f32 v59, v59
    v_smfmac_f32_32x32x32_bf16 v[64:79], v[196:199], v[40:47], v5
    ds_write_b128 v8, v[116:119] offset:1024
    v_exp_f32 v60, v60
    v_exp_f32 v61, v61
    v_exp_f32 v62, v62
    v_exp_f32 v63, v63
    ds_write_b128 v8, v[120:123] offset:2048
    v_exp_f32 v16, v16
    v_exp_f32 v17, v17
    v_exp_f32 v18, v18
    v_exp_f32 v19, v19
    ds_write_b128 v8, v[124:127] offset:3072
    v_exp_f32 v20, v20
    v_exp_f32 v21, v21
    v_exp_f32 v22, v22
    v_exp_f32 v23, v23
    v_smfmac_f32_32x32x32_bf16 v[64:79], a[192:195], v[48:55], v5
    global_load_dwordx4 a[200:203], v1, s[40:41] offset:0 sc1
    global_load_dwordx4 a[204:207], v1, s[40:41] offset:1024 sc1
    v_exp_f32 v24, v24
    v_exp_f32 v25, v25
    v_exp_f32 v26, v26
    v_exp_f32 v27, v27
    v_smfmac_f32_32x32x32_bf16 v[64:79], a[196:199], v[56:63], v5
    s_waitcnt lgkmcnt(0)
    s_barrier
    ds_read_b128 v[92:95], v9 offset:3072
    ds_read_b128 v[108:111], v9 offset:7168
    v_exp_f32 v28, v28
    v_exp_f32 v29, v29
    v_exp_f32 v30, v30
    v_exp_f32 v31, v31
    v_smfmac_f32_32x32x32_bf16 v[64:79], a[184:187], v[16:23], v5
    ds_read_b128 v[124:127], v9 offset:11264
    ds_read_b128 v[80:83], v9 offset:0
    v_smfmac_f32_32x32x32_bf16 v[64:79], a[188:191], v[24:31], v5
    ds_read_b128 v[96:99], v9 offset:4096
    ds_read_b128 v[112:115], v9 offset:8192
    ds_read_b128 v[84:87], v9 offset:1024
    ds_read_b128 v[100:103], v9 offset:5120
    ds_read_b128 v[116:119], v9 offset:9216
    ds_read_b128 v[88:91], v9 offset:2048
    ds_read_b128 v[104:107], v9 offset:6144
    ds_read_b128 v[120:123], v9 offset:10240
    global_load_dwordx4 v[192:195], v1, s[40:41] offset:2048 sc1
    global_load_dwordx4 v[196:199], v1, s[40:41] offset:3072 sc1
    s_add_u32 s40, s40, 8192
    s_addc_u32 s41, s41, 0
    global_load_dwordx4 a[248:251], v1, s[40:41] offset:-4096 sc1
    s_waitcnt lgkmcnt(9)
    v_pk_add_f32 v[108:109], v[108:109], v[124:125]
    v_pk_add_f32 v[110:111], v[110:111], v[126:127]
    v_pk_add_f32 v[92:93], v[92:93], v[108:109]
    v_pk_add_f32 v[94:95], v[94:95], v[110:111]
    v_pk_add_f32 v[76:77], v[76:77], v[92:93]
    v_pk_add_f32 v[78:79], v[78:79], v[94:95]
    v_mov_b32 v14, v76
    v_mov_b32 v15, v76
    s_waitcnt lgkmcnt(6)
    v_pk_add_f32 v[96:97], v[96:97], v[112:113]
    v_pk_add_f32 v[98:99], v[98:99], v[114:115]
    v_permlane32_swap_b32 v14, v15
    v_pk_add_f32 v[64:65], v[64:65], v[80:81]
    v_pk_add_f32 v[66:67], v[66:67], v[82:83]
    v_rcp_f32 v14, v15
    s_mov_b32 s3, 0x71800000
    v_min_f32 v4, s3, v15
    v_max_f32 v4, 0x21800000, v4
    v_cmp_eq_f32 vcc, v4, v15
    v_pk_add_f32 v[64:65], v[64:65], v[96:97]
    v_pk_add_f32 v[66:67], v[66:67], v[98:99]
    v_cndmask_b32 v14, -1, v14, vcc
    global_load_dwordx4 a[252:255], v1, s[40:41] offset:-3072 sc1
    s_waitcnt lgkmcnt(0)
    v_pk_add_f32 v[100:101], v[100:101], v[116:117]
    v_pk_add_f32 v[102:103], v[102:103], v[118:119]
    v_pk_add_f32 v[68:69], v[68:69], v[84:85]
    v_pk_add_f32 v[70:71], v[70:71], v[86:87]
    v_pk_add_f32 v[68:69], v[68:69], v[100:101]
    v_pk_add_f32 v[70:71], v[70:71], v[102:103]
    v_pk_add_f32 v[104:105], v[104:105], v[120:121]
    v_pk_add_f32 v[106:107], v[106:107], v[122:123]
    v_pk_add_f32 v[72:73], v[72:73], v[88:89]
    v_pk_add_f32 v[74:75], v[74:75], v[90:91]
    v_pk_add_f32 v[72:73], v[72:73], v[104:105]
    v_pk_add_f32 v[74:75], v[74:75], v[106:107]
    global_load_dwordx4 v[128:131], v1, s[40:41] offset:-2048 sc1
    v_pk_mul_f32 v[76:77], v[14:15], v[76:77] op_sel_hi:[0,1]
    v_pk_mul_f32 v[78:79], v[14:15], v[78:79] op_sel_hi:[0,1]
    v_cvt_pk_bf16_f32 v86, v76, v77
    v_cvt_pk_bf16_f32 v87, v78, v79
    ds_write_b64 v3, v[86:87]
    v_pk_mul_f32 v[64:65], v[14:15], v[64:65] op_sel_hi:[0,1]
    v_pk_mul_f32 v[66:67], v[14:15], v[66:67] op_sel_hi:[0,1]
    v_cvt_pk_bf16_f32 v80, v64, v65
    v_cvt_pk_bf16_f32 v81, v66, v67
    ds_write_b64 v2, v[80:81] offset:0
    v_pk_mul_f32 v[68:69], v[14:15], v[68:69] op_sel_hi:[0,1]
    v_pk_mul_f32 v[70:71], v[14:15], v[70:71] op_sel_hi:[0,1]
    v_cvt_pk_bf16_f32 v82, v68, v69
    v_cvt_pk_bf16_f32 v83, v70, v71
    ds_write_b64 v2, v[82:83] offset:16
    v_pk_mul_f32 v[72:73], v[14:15], v[72:73] op_sel_hi:[0,1]
    v_pk_mul_f32 v[74:75], v[14:15], v[74:75] op_sel_hi:[0,1]
    v_cvt_pk_bf16_f32 v84, v72, v73
    v_cvt_pk_bf16_f32 v85, v74, v75
    ds_write_b64 v2, v[84:85] offset:32
    global_load_dwordx4 v[132:135], v1, s[40:41] offset:-1024 sc1
    v_mov_b64 v[96:97], 0
    v_mov_b64 v[98:99], 0
    v_mov_b64 v[100:101], 0
    v_mov_b64 v[102:103], 0
    v_mov_b64 v[104:105], 0
    v_mov_b64 v[106:107], 0
    v_mov_b64 v[108:109], 0
    v_mov_b64 v[110:111], 0
    v_mov_b64 v[112:113], 0
    v_mov_b64 v[114:115], 0
    v_mov_b64 v[116:117], 0
    v_mov_b64 v[118:119], 0
    v_mov_b64 v[120:121], 0
    v_mov_b64 v[122:123], 0
    s_add_u32 s40, s40, 8192
    s_addc_u32 s41, s41, 0
    global_load_dwordx4 a[192:195], v1, s[40:41] offset:-4096 sc1
    s_waitcnt lgkmcnt(0)
    s_barrier
    ds_read_b128 v[64:67], v10 offset:0
    ds_read_b128 v[68:71], v10 offset:128
    ds_read_b128 v[72:75], v10 offset:256
    ds_read_b128 v[76:79], v10 offset:384
    ds_read_b128 v[80:83], v10 offset:512
    ds_read_b128 v[84:87], v10 offset:640
    ds_read_b128 v[88:91], v10 offset:768
    global_load_dwordx4 a[196:199], v1, s[40:41] offset:-3072 sc1
    v_lshlrev_b32 v40, 16, v208
    v_and_b32 v41, 0xffff0000, v208
    v_lshlrev_b32 v42, 16, v209
    v_and_b32 v43, 0xffff0000, v209
    v_lshlrev_b32 v44, 16, v210
    v_and_b32 v45, 0xffff0000, v210
    v_lshlrev_b32 v46, 16, v211
    v_and_b32 v47, 0xffff0000, v211
    v_lshlrev_b32 v48, 16, v212
    v_and_b32 v49, 0xffff0000, v212
    global_load_dwordx4 a[184:187], v1, s[40:41] offset:-2048 sc1
    v_lshlrev_b32 v50, 16, v213
    v_and_b32 v51, 0xffff0000, v213
    v_lshlrev_b32 v52, 16, v214
    v_and_b32 v53, 0xffff0000, v214
    v_lshlrev_b32 v54, 16, v215
    v_and_b32 v55, 0xffff0000, v215
    s_waitcnt lgkmcnt(4)
    v_smfmac_f32_16x16x64_bf16 v[96:99], v[64:67], a[0:7], v218
    global_load_dwordx4 a[188:191], v1, s[40:41] offset:-1024 sc1
    v_smfmac_f32_16x16x64_bf16 v[96:99], v[68:71], a[56:63], v218
    v_smfmac_f32_16x16x64_bf16 v[96:99], v[72:75], a[112:119], v218
    s_waitcnt lgkmcnt(0)
    v_smfmac_f32_16x16x64_bf16 v[96:99], v[76:79], a[120:127], v218
    global_load_dwordx4 v[16:19], v1, s[40:41] offset:0 sc1
    v_smfmac_f32_16x16x64_bf16 v[96:99], v[80:83], a[128:135], v218
    v_smfmac_f32_16x16x64_bf16 v[96:99], v[84:87], a[136:143], v218
    v_smfmac_f32_16x16x64_bf16 v[96:99], v[88:91], a[144:151], v218
    v_smfmac_f32_16x16x64_bf16 v[100:103], v[64:67], a[8:15], v218
    global_load_dwordx4 v[20:23], v1, s[40:41] offset:1024 sc1
    v_smfmac_f32_16x16x64_bf16 v[100:103], v[68:71], a[64:71], v218
    v_smfmac_f32_16x16x64_bf16 v[100:103], v[72:75], a[152:159], v218
    v_smfmac_f32_16x16x64_bf16 v[100:103], v[76:79], a[160:167], v218
    global_load_dwordx4 v[24:27], v1, s[40:41] offset:2048 sc1
    v_smfmac_f32_16x16x64_bf16 v[100:103], v[80:83], a[168:175], v218
    s_nop 0
    v_permlane32_swap_b32 v96, v98
    v_smfmac_f32_16x16x64_bf16 v[100:103], v[84:87], a[176:183], v218
    v_permlane32_swap_b32 v97, v99
    v_smfmac_f32_16x16x64_bf16 v[100:103], v[88:91], v[224:231], v218
    v_add_f32 v96, v96, v98
    v_smfmac_f32_16x16x64_bf16 v[104:107], v[64:67], a[16:23], v218
    global_load_dwordx4 v[28:31], v1, s[40:41] offset:3072 sc1
    v_smfmac_f32_16x16x64_bf16 v[104:107], v[68:71], a[72:79], v218
    v_add_f32 v97, v97, v99
    s_waitcnt vmcnt(59)
    v_smfmac_f32_16x16x64_bf16 v[104:107], v[72:75], v[248:255], v218
    ds_write2_b32 v216, v96, v97 offset0:0 offset1:116
    v_smfmac_f32_16x16x64_bf16 v[104:107], v[76:79], v[232:239], v218
    s_add_u32 s40, s40, 8192
    s_addc_u32 s41, s41, 0
    global_load_dwordx4 v[32:35], v1, s[40:41] offset:-4096 sc1
    v_smfmac_f32_16x16x64_bf16 v[104:107], v[80:83], a[240:247], v218
    v_permlane32_swap_b32 v100, v102
    v_smfmac_f32_16x16x64_bf16 v[104:107], v[84:87], v[240:247], v218
    v_permlane32_swap_b32 v101, v103
    v_smfmac_f32_16x16x64_bf16 v[104:107], v[88:91], v[168:175], v218
    v_add_f32 v100, v100, v102
    v_smfmac_f32_16x16x64_bf16 v[108:111], v[64:67], a[24:31], v218
    global_load_dwordx4 v[36:39], v1, s[40:41] offset:-3072 sc1
    v_smfmac_f32_16x16x64_bf16 v[108:111], v[68:71], a[80:87], v218
    v_add_f32 v101, v101, v103
    s_waitcnt vmcnt(47)
    v_smfmac_f32_16x16x64_bf16 v[108:111], v[72:75], v[200:207], v218
    ds_write2_b32 v216, v100, v101 offset0:16 offset1:132
    v_smfmac_f32_16x16x64_bf16 v[108:111], v[76:79], v[176:183], v218
    v_smfmac_f32_16x16x64_bf16 v[108:111], v[80:83], a[232:239], v218
    v_permlane32_swap_b32 v104, v106
    v_smfmac_f32_16x16x64_bf16 v[108:111], v[84:87], a[224:231], v218
    v_permlane32_swap_b32 v105, v107
    v_smfmac_f32_16x16x64_bf16 v[108:111], v[88:91], v[184:191], v218
    v_add_f32 v104, v104, v106
    v_smfmac_f32_16x16x64_bf16 v[112:115], v[64:67], a[32:39], v218
    s_add_u32 m0, s58, 86016
    s_nop 0
    buffer_load_dwordx4 v1, s[44:47], m0 offen offset:0 sc1 lds
    v_smfmac_f32_16x16x64_bf16 v[112:115], v[68:71], a[88:95], v218
    v_add_f32 v105, v105, v107
    s_waitcnt vmcnt(21)
    v_smfmac_f32_16x16x64_bf16 v[112:115], v[72:75], a[216:223], v218
    ds_write2_b32 v216, v104, v105 offset0:32 offset1:148
    v_smfmac_f32_16x16x64_bf16 v[112:115], v[76:79], a[208:215], v218
    v_smfmac_f32_16x16x64_bf16 v[112:115], v[80:83], v[136:143], v218
    v_permlane32_swap_b32 v108, v110
    v_smfmac_f32_16x16x64_bf16 v[112:115], v[84:87], v[144:151], v218
    v_permlane32_swap_b32 v109, v111
    v_smfmac_f32_16x16x64_bf16 v[112:115], v[88:91], v[152:159], v218
    v_add_f32 v108, v108, v110
    v_smfmac_f32_16x16x64_bf16 v[116:119], v[64:67], a[40:47], v218
    buffer_load_dwordx4 v1, s[44:47], m0 offen offset:1024 sc1 lds
    v_smfmac_f32_16x16x64_bf16 v[116:119], v[68:71], a[96:103], v218
    v_add_f32 v109, v109, v111
    s_waitcnt vmcnt(16)
    v_smfmac_f32_16x16x64_bf16 v[116:119], v[72:75], v[160:167], v218
    ds_write2_b32 v216, v108, v109 offset0:48 offset1:164
    v_smfmac_f32_16x16x64_bf16 v[116:119], v[76:79], a[200:207], v218
    v_smfmac_f32_16x16x64_bf16 v[116:119], v[80:83], v[192:199], v218
    v_permlane32_swap_b32 v112, v114
    s_waitcnt vmcnt(12)
    v_smfmac_f32_16x16x64_bf16 v[116:119], v[84:87], a[248:255], v218
    v_permlane32_swap_b32 v113, v115
    v_smfmac_f32_16x16x64_bf16 v[116:119], v[88:91], v[128:135], v218
    v_add_f32 v112, v112, v114
    v_smfmac_f32_16x16x64_bf16 v[120:123], v[64:67], a[48:55], v218
    buffer_load_dwordx4 v1, s[44:47], m0 offen offset:2048 sc1 lds
    v_smfmac_f32_16x16x64_bf16 v[120:123], v[68:71], a[104:111], v218
    v_add_f32 v113, v113, v115
    s_waitcnt vmcnt(7)
    v_smfmac_f32_16x16x64_bf16 v[120:123], v[72:75], a[192:199], v218
    ds_write2_b32 v216, v112, v113 offset0:64 offset1:180
    v_smfmac_f32_16x16x64_bf16 v[120:123], v[76:79], a[184:191], v218
    v_smfmac_f32_16x16x64_bf16 v[120:123], v[80:83], v[16:23], v218
    v_permlane32_swap_b32 v116, v118
    s_waitcnt vmcnt(3)
    v_smfmac_f32_16x16x64_bf16 v[120:123], v[84:87], v[24:31], v218
    v_permlane32_swap_b32 v117, v119
    v_smfmac_f32_16x16x64_bf16 v[120:123], v[88:91], v[32:39], v218
    v_add_f32 v116, v116, v118
    v_add_f32 v117, v117, v119
    ds_write2_b32 v216, v116, v117 offset0:80 offset1:196
    s_add_u32 m0, s58, 89088
    s_nop 0
    buffer_load_dwordx4 v1, s[44:47], m0 offen offset:0 sc1 lds
    s_nop 1
    v_permlane32_swap_b32 v120, v122
    v_permlane32_swap_b32 v121, v123
    v_add_f32 v120, v120, v122
    v_add_f32 v121, v121, v123
    ds_write2_b32 v216, v120, v121 offset0:96 offset1:212
    ds_read_b128 v[64:67], v217 offset:0
    ds_read_b128 v[68:71], v217 offset:16
    ds_read_b128 v[72:75], v217 offset:32
    ds_read_b128 v[76:79], v217 offset:48
    buffer_load_dwordx4 v1, s[44:47], m0 offen offset:1024 sc1 lds
    s_mov_b32 vcc_lo, -1
    s_mov_b32 vcc_hi, 0x00ffffff
    s_waitcnt lgkmcnt(2)
    v_pk_add_f32 v[64:65], v[64:65], v[40:41]
    v_pk_add_f32 v[66:67], v[66:67], v[42:43]
    v_pk_add_f32 v[68:69], v[68:69], v[44:45]
    v_pk_add_f32 v[70:71], v[70:71], v[46:47]
    s_waitcnt lgkmcnt(0)
    v_pk_add_f32 v[72:73], v[72:73], v[48:49]
    v_pk_add_f32 v[74:75], v[74:75], v[50:51]
    v_pk_add_f32 v[76:77], v[76:77], v[52:53]
    v_pk_add_f32 v[78:79], v[78:79], v[54:55]
    v_pk_add_f32 v[56:57], v[64:65], v[66:67]
    v_pk_mul_f32 v[58:59], v[64:65], v[64:65]
    v_pk_fma_f32 v[58:59], v[66:67], v[66:67], v[58:59]
    v_pk_add_f32 v[56:57], v[56:57], v[68:69]
    v_pk_fma_f32 v[58:59], v[68:69], v[68:69], v[58:59]
    v_pk_add_f32 v[56:57], v[56:57], v[70:71]
    v_pk_fma_f32 v[58:59], v[70:71], v[70:71], v[58:59]
    v_pk_add_f32 v[56:57], v[56:57], v[72:73]
    v_pk_fma_f32 v[58:59], v[72:73], v[72:73], v[58:59]
    v_pk_add_f32 v[56:57], v[56:57], v[74:75]
    v_pk_fma_f32 v[58:59], v[74:75], v[74:75], v[58:59]
    v_pk_add_f32 v[56:57], v[56:57], v[76:77]
    v_pk_fma_f32 v[58:59], v[76:77], v[76:77], v[58:59]
    v_pk_add_f32 v[56:57], v[56:57], v[78:79]
    v_pk_fma_f32 v[58:59], v[78:79], v[78:79], v[58:59]
    v_add_f32 v14, v56, v57
    v_add_f32 v15, v58, v59
    v_cndmask_b32 v14, 0, v14, vcc
    v_cndmask_b32 v15, 0, v15, vcc
    v_cvt_pk_bf16_f32 v80, v64, v65
    v_cvt_pk_bf16_f32 v81, v66, v67
    v_permlane32_swap_b32 v14, v15
    v_add_f32 v14, v14, v15
    v_mov_b32 v15, v14
    v_cvt_pk_bf16_f32 v82, v68, v69
    v_cvt_pk_bf16_f32 v83, v70, v71
    v_permlane16_swap_b32 v14, v15
    v_add_f32 v14, v14, v15
    v_cvt_pk_bf16_f32 v84, v72, v73
    v_cvt_pk_bf16_f32 v85, v74, v75
    v_add_f32_dpp v14, v14, v14 row_ror:8 row_mask:0xf bank_mask:0xf
    ds_write_b32 v11, v14
    v_cvt_pk_bf16_f32 v86, v76, v77
    v_cvt_pk_bf16_f32 v87, v78, v79
    global_store_dwordx4 v219, v[80:83], s[26:27] offset:0 sc1
    global_store_dwordx4 v219, v[84:87], s[26:27] offset:512 sc1
    s_waitcnt lgkmcnt(0)
    s_barrier
    ds_read_b128 v[56:59], v222
    ds_read_b128 v[60:63], v222 offset:16
    v_mov_b32 v15, 0x3727c5ac
    s_waitcnt lgkmcnt(0)
    v_pk_add_f32 v[56:57], v[56:57], v[58:59]
    v_pk_add_f32 v[60:61], v[60:61], v[62:63]
    v_add_f32 v56, v56, v57
    v_add_f32 v60, v60, v61
    v_cmp_class_f32 vcc, v56, s59
    s_cbranch_vccnz L_exact
L_exact_done:
    v_mul_f32 v56, 0xbb124925, v56
    v_fmamk_f32 v60, v60, 0x3b124925, v15
    v_fma_f32 v60, -v56, v56, v60
    v_max_f32 v60, v15, v60
    v_rsq_f32 v60, v60
    v_mul_f32 v56, 0xbeeff558, v56
    v_mul_f32 v56, v56, v60
    v_mul_f32 v60, 0xbeeff558, v60
    v_pk_fma_f32 v[64:65], v[60:61], v[64:65], v[56:57] op_sel_hi:[0,1,0]
    v_pk_fma_f32 v[66:67], v[60:61], v[66:67], v[56:57] op_sel_hi:[0,1,0]
    v_pk_fma_f32 v[68:69], v[60:61], v[68:69], v[56:57] op_sel_hi:[0,1,0]
    v_pk_fma_f32 v[70:71], v[60:61], v[70:71], v[56:57] op_sel_hi:[0,1,0]
    v_cvt_pk_bf16_f32 v88, v64, v65
    v_cvt_pk_bf16_f32 v89, v66, v67
    v_cvt_pk_bf16_f32 v90, v68, v69
    v_cvt_pk_bf16_f32 v91, v70, v71
    global_store_dwordx4 v223, v[88:91], s[26:27] offset:0 sc1
    v_pk_fma_f32 v[72:73], v[60:61], v[72:73], v[56:57] op_sel_hi:[0,1,0]
    v_pk_fma_f32 v[74:75], v[60:61], v[74:75], v[56:57] op_sel_hi:[0,1,0]
    v_pk_fma_f32 v[76:77], v[60:61], v[76:77], v[56:57] op_sel_hi:[0,1,0]
    v_pk_fma_f32 v[78:79], v[60:61], v[78:79], v[56:57] op_sel_hi:[0,1,0]
    v_cvt_pk_bf16_f32 v92, v72, v73
    v_cvt_pk_bf16_f32 v93, v74, v75
    v_cvt_pk_bf16_f32 v94, v76, v77
    v_cvt_pk_bf16_f32 v95, v78, v79
    global_store_dwordx4 v223, v[92:95], s[26:27] offset:512 sc1
    s_min_u32 s3, s32, 6
    s_lshl2_add_u32 s3, s3, s28
    s_mul_i32 s3, s3, 56*1024
    s_add_u32 s3, s3, 6033408
    s_add_u32 s40, s26, s3
    s_addc_u32 s41, s27, 0
    s_and_b32 s3, s28, 1
    s_lshl_b32 s3, s3, 8
    s_lshr_b32 s62, s28, 1
    s_lshl_b32 s62, s62, 10
    s_or_b32 s3, s3, s62
    v_and_b32 v6, 0xf0, v1
    v_bfe_u32 v7, v0, 4, 1
    v_lshl_or_b32 v6, v7, 9, v6
    v_lshrrev_b32 v7, 5, v0
    v_lshl_or_b32 v2, v7, 11, v6
    v_lshl_or_b32 v6, v7, 10, v6
    v_or_b32 v2, s3, v2
    s_cmp_eq_u32 s32, 7
    s_cselect_b32 s3, 0, -1
    v_and_b32 v2, s3, v2
    v_and_b32 v6, s3, v6
    v_xor_b32 v3, 0x100, v2
    v_xor_b32 v7, 0x400, v2
L_pad3:
    s_cbranch_execz L_back0
    v_xor_b32 v11, 0x500, v2
    s_lshl2_add_u32 s3, s34, s28
    s_and_b32 s62, s35, 3
    s_lshl2_add_u32 s56, s3, s62
    s_lshl_b32 s56, s56, 7
    s_add_u32 s56, s56, 65564
    s_mul_i32 s62, s3, 28*1024
    s_add_u32 s62, s62, 7671808
    s_add_u32 s36, s26, s62
    s_addc_u32 s37, s27, 0
    s_lshr_b32 s62, s35, 2
    s_lshl2_add_u32 s3, s3, s62
    s_mul_i32 s3, s3, 28
    s_and_b32 s62, s35, 3
    s_add_u32 s3, s3, s62
    s_lshl_b32 s3, s3, 10
    s_add_u32 s3, s3, 11341824
    s_add_u32 s38, s26, s3
    s_addc_u32 s39, s27, 0
    s_lshr_b32 s61, s28, 1
    s_lshl1_add_u32 s61, s34, s61
    s_lshr_b32 s62, s35, 2
    s_lshl2_add_u32 s61, s61, s62
    s_lshl_b32 s61, s61, 7
    s_add_u32 s61, s61, 65536
    v_and_b32 v12, 0xf0, v1
    buffer_load_dwordx4 v1, s[44:47], m0 offen offset:2048 sc1 lds
    v_bfe_u32 v4, v0, 4, 1
    v_lshl_or_b32 v12, v4, 9, v12
    v_lshrrev_b32 v4, 5, v0
    v_lshl_or_b32 v13, v4, 8, v12
    v_lshl_or_b32 v12, v4, 10, v12
    v_add_u32 v4, 57344, v12
    buffer_load_dwordx4 v1, s[44:47], m0 offen offset:3072 sc1 lds
    v_add_u32 v5, 114688, v12
    v_mov_b32 v9, 0x409d30fc
    v_mov_b32 v8, 0x3e60ec05
    s_lshl2_add_u32 s57, s31, s28
    s_lshl_b32 s57, s57, 7
    s_add_u32 s57, s57, 65536
    s_lshl3_add_u32 s3, s31, s28
    s_mul_i32 s3, s3, 28*1024
    s_add_u32 s3, s3, 11341824
    s_add_u32 s52, s26, s3
    s_addc_u32 s53, s27, 0
    s_add_u32 s54, s52, 114688
    s_addc_u32 s55, s53, 0
    s_lshr_b32 s62, s33, 2
    s_lshl2_add_u32 s62, s62, s28
    s_lshl_b32 s62, s62, 7
    s_add_u32 s62, s62, 65564
    s_add_u32 m0, s58, 114688
    s_nop 0
    buffer_load_dwordx4 v1, s[44:47], m0 offen offset:0 sc1 lds
    buffer_load_dwordx4 v1, s[44:47], m0 offen offset:1024 sc1 lds
    buffer_load_dwordx4 v1, s[44:47], m0 offen offset:2048 sc1 lds
    s_add_u32 m0, s58, 117760
    s_nop 0
    buffer_load_dwordx4 v1, s[44:47], m0 offen offset:0 sc1 lds
    s_mov_b64 exec, 0
    s_cmp_eq_u32 s28, 0
    s_cbranch_scc1 L_pad4
    s_cmp_eq_u32 s28, 1
    s_cbranch_scc1 L_pad5
    s_cmp_eq_u32 s28, 2
    s_cbranch_scc1 L_pad6
    s_cmp_eq_u32 s28, 3
    s_cbranch_scc1 L_pad7
L_pad7:
L_back1:
    s_mov_b64 exec, -1
    s_lshl2_add_u32 s3, s2, s28
    s_cmp_lg_u32 s3, 0
    s_cbranch_scc1 L_noep
    v_lshlrev_b32 v10, 3, v0
    v_add_u32 v10, 36864, v10
    v_mov_b32 v14, s68
    v_mov_b32 v15, s69
    s_mov_b64 exec, 7
    global_store_dwordx2 v10, v[14:15], s[26:27] sc1
    s_mov_b64 exec, -1
L_noep:
    s_waitcnt vmcnt(6)
    s_barrier
    s_atomic_add s25, s[26:27], s62 offset:0
    buffer_load_dwordx4 v1, s[44:47], m0 offen offset:1024 sc1 lds
    buffer_load_dwordx4 v1, s[44:47], m0 offen offset:2048 sc1 lds
    buffer_load_dwordx4 v1, s[44:47], m0 offen offset:3072 sc1 lds
    global_load_dwordx4 a[112:115], v2, s[40:41] offset:-4096 sc1
    global_load_dwordx4 a[116:119], v3, s[40:41] offset:-4096 sc1
    global_load_dwordx4 a[120:123], v7, s[40:41] offset:-4096 sc1
    global_load_dwordx4 a[124:127], v11, s[40:41] offset:-4096 sc1
    global_load_dwordx4 a[128:131], v2, s[40:41] offset:0 sc1
    global_load_dwordx4 a[132:135], v3, s[40:41] offset:0 sc1
    global_load_dwordx4 a[136:139], v7, s[40:41] offset:0 sc1
    global_load_dwordx4 a[140:143], v11, s[40:41] offset:0 sc1
    s_mov_b32 s3, 262144
L_poll_4013:
    s_load_dword s4, s[26:27], s56 glc
    s_waitcnt lgkmcnt(0)
    s_cmp_lg_u32 s4, 4
    s_cbranch_scc0 L_polld_4014
    s_sub_u32 s3, s3, 1
    s_cbranch_scc0 L_poll_4013
L_polld_4014:
L_h_ok:
    global_load_dwordx4 a[0:3], v12, s[36:37] offset:-4096 sc1
    global_load_dwordx4 a[4:7], v12, s[36:37] offset:-3840 sc1
    global_load_dwordx4 a[8:11], v12, s[36:37] offset:-2048 sc1
    global_load_dwordx4 a[12:15], v12, s[36:37] offset:-1792 sc1
    global_load_dwordx4 a[16:19], v12, s[36:37] offset:0 sc1
    global_load_dwordx4 a[20:23], v12, s[36:37] offset:256 sc1
    global_load_dwordx4 a[24:27], v12, s[36:37] offset:2048 sc1
    global_load_dwordx4 a[28:31], v12, s[36:37] offset:2304 sc1
    s_add_u32 s36, s36, 8192
    s_addc_u32 s37, s37, 0
    global_load_dwordx4 a[32:35], v12, s[36:37] offset:-4096 sc1
    global_load_dwordx4 a[36:39], v12, s[36:37] offset:-3840 sc1
    global_load_dwordx4 a[40:43], v12, s[36:37] offset:-2048 sc1
    s_waitcnt vmcnt(19)
    s_barrier
    ds_read_b128 v[80:83], v12 offset:0
    ds_read_b128 v[84:87], v12 offset:28672
    ds_read_b128 v[88:91], v12 offset:256
    ds_read_b128 v[92:95], v12 offset:28928
    ds_read_b128 v[96:99], v12 offset:2048
    ds_read_b128 v[100:103], v12 offset:30720
    s_waitcnt vmcnt(10) lgkmcnt(5)
    v_mfma_f32_16x16x32_bf16 v[16:19], v[80:83], a[0:3], 0
    ds_read_b128 v[104:107], v12 offset:2304
    s_waitcnt vmcnt(9)
    v_mfma_f32_16x16x32_bf16 v[20:23], v[80:83], a[4:7], 0
    global_load_dwordx4 a[44:47], v12, s[36:37] offset:-1792 sc1
    s_waitcnt lgkmcnt(5)
    v_mfma_f32_16x16x32_bf16 v[32:35], v[84:87], a[0:3], 0
    s_waitcnt lgkmcnt(3)
    ds_read_b128 v[108:111], v12 offset:30976
    v_mfma_f32_16x16x32_bf16 v[36:39], v[84:87], a[4:7], 0
    v_mfma_f32_16x16x32_bf16 v[24:27], v[88:91], a[0:3], 0
    ds_read_b128 v[80:83], v12 offset:4096
    v_mfma_f32_16x16x32_bf16 v[28:31], v[88:91], a[4:7], 0
    global_load_dwordx4 a[48:51], v12, s[36:37] offset:0 sc1
    v_mfma_f32_16x16x32_bf16 v[40:43], v[92:95], a[0:3], 0
    s_waitcnt lgkmcnt(3)
    ds_read_b128 v[84:87], v12 offset:32768
    v_mfma_f32_16x16x32_bf16 v[44:47], v[92:95], a[4:7], 0
    s_waitcnt vmcnt(10)
    v_mfma_f32_16x16x32_bf16 v[16:19], v[96:99], a[8:11], v[16:19]
    ds_read_b128 v[88:91], v12 offset:4352
    s_waitcnt vmcnt(9)
    v_mfma_f32_16x16x32_bf16 v[20:23], v[96:99], a[12:15], v[20:23]
    global_load_dwordx4 a[52:55], v12, s[36:37] offset:256 sc1
    v_mfma_f32_16x16x32_bf16 v[32:35], v[100:103], a[8:11], v[32:35]
    s_waitcnt lgkmcnt(3)
    ds_read_b128 v[92:95], v12 offset:33024
    v_mfma_f32_16x16x32_bf16 v[36:39], v[100:103], a[12:15], v[36:39]
    v_mfma_f32_16x16x32_bf16 v[24:27], v[104:107], a[8:11], v[24:27]
    ds_read_b128 v[96:99], v12 offset:6144
    v_mfma_f32_16x16x32_bf16 v[28:31], v[104:107], a[12:15], v[28:31]
    global_load_dwordx4 a[56:59], v12, s[36:37] offset:2048 sc1
    v_mfma_f32_16x16x32_bf16 v[40:43], v[108:111], a[8:11], v[40:43]
    s_waitcnt lgkmcnt(3)
    ds_read_b128 v[100:103], v12 offset:34816
    v_mfma_f32_16x16x32_bf16 v[44:47], v[108:111], a[12:15], v[44:47]
    s_waitcnt vmcnt(10)
    v_mfma_f32_16x16x32_bf16 v[16:19], v[80:83], a[16:19], v[16:19]
    ds_read_b128 v[104:107], v12 offset:6400
    s_waitcnt vmcnt(9)
    v_mfma_f32_16x16x32_bf16 v[20:23], v[80:83], a[20:23], v[20:23]
    global_load_dwordx4 a[60:63], v12, s[36:37] offset:2304 sc1
    v_mfma_f32_16x16x32_bf16 v[32:35], v[84:87], a[16:19], v[32:35]
    s_waitcnt lgkmcnt(3)
    ds_read_b128 v[108:111], v12 offset:35072
    v_mfma_f32_16x16x32_bf16 v[36:39], v[84:87], a[20:23], v[36:39]
    v_mfma_f32_16x16x32_bf16 v[24:27], v[88:91], a[16:19], v[24:27]
    ds_read_b128 v[80:83], v12 offset:8192
    v_mfma_f32_16x16x32_bf16 v[28:31], v[88:91], a[20:23], v[28:31]
    s_add_u32 s36, s36, 8192
    s_addc_u32 s37, s37, 0
    global_load_dwordx4 a[64:67], v12, s[36:37] offset:-4096 sc1
    v_mfma_f32_16x16x32_bf16 v[40:43], v[92:95], a[16:19], v[40:43]
    s_waitcnt lgkmcnt(3)
    ds_read_b128 v[84:87], v12 offset:36864
    v_mfma_f32_16x16x32_bf16 v[44:47], v[92:95], a[20:23], v[44:47]
    s_waitcnt vmcnt(10)
    v_mfma_f32_16x16x32_bf16 v[16:19], v[96:99], a[24:27], v[16:19]
    ds_read_b128 v[88:91], v12 offset:8448
    s_waitcnt vmcnt(9)
    v_mfma_f32_16x16x32_bf16 v[20:23], v[96:99], a[28:31], v[20:23]
    global_load_dwordx4 a[68:71], v12, s[36:37] offset:-3840 sc1
    v_mfma_f32_16x16x32_bf16 v[32:35], v[100:103], a[24:27], v[32:35]
    s_waitcnt lgkmcnt(3)
    ds_read_b128 v[92:95], v12 offset:37120
    v_mfma_f32_16x16x32_bf16 v[36:39], v[100:103], a[28:31], v[36:39]
    v_mfma_f32_16x16x32_bf16 v[24:27], v[104:107], a[24:27], v[24:27]
    ds_read_b128 v[96:99], v12 offset:10240
    v_mfma_f32_16x16x32_bf16 v[28:31], v[104:107], a[28:31], v[28:31]
    global_load_dwordx4 a[72:75], v12, s[36:37] offset:-2048 sc1
    v_mfma_f32_16x16x32_bf16 v[40:43], v[108:111], a[24:27], v[40:43]
    s_waitcnt lgkmcnt(3)
    ds_read_b128 v[100:103], v12 offset:38912
    v_mfma_f32_16x16x32_bf16 v[44:47], v[108:111], a[28:31], v[44:47]
    s_waitcnt vmcnt(10)
    v_mfma_f32_16x16x32_bf16 v[16:19], v[80:83], a[32:35], v[16:19]
    ds_read_b128 v[104:107], v12 offset:10496
    s_waitcnt vmcnt(9)
    v_mfma_f32_16x16x32_bf16 v[20:23], v[80:83], a[36:39], v[20:23]
    global_load_dwordx4 a[76:79], v12, s[36:37] offset:-1792 sc1
    v_mfma_f32_16x16x32_bf16 v[32:35], v[84:87], a[32:35], v[32:35]
    s_waitcnt lgkmcnt(3)
    ds_read_b128 v[108:111], v12 offset:39168
    v_mfma_f32_16x16x32_bf16 v[36:39], v[84:87], a[36:39], v[36:39]
    v_mfma_f32_16x16x32_bf16 v[24:27], v[88:91], a[32:35], v[24:27]
    ds_read_b128 v[80:83], v12 offset:12288
    v_mfma_f32_16x16x32_bf16 v[28:31], v[88:91], a[36:39], v[28:31]
    global_load_dwordx4 a[80:83], v12, s[36:37] offset:0 sc1
    v_mfma_f32_16x16x32_bf16 v[40:43], v[92:95], a[32:35], v[40:43]
    s_waitcnt lgkmcnt(3)
    ds_read_b128 v[84:87], v12 offset:40960
    v_mfma_f32_16x16x32_bf16 v[44:47], v[92:95], a[36:39], v[44:47]
    s_waitcnt vmcnt(10)
    v_mfma_f32_16x16x32_bf16 v[16:19], v[96:99], a[40:43], v[16:19]
    ds_read_b128 v[88:91], v12 offset:12544
    s_waitcnt vmcnt(9)
    v_mfma_f32_16x16x32_bf16 v[20:23], v[96:99], a[44:47], v[20:23]
    global_load_dwordx4 a[84:87], v12, s[36:37] offset:256 sc1
    v_mfma_f32_16x16x32_bf16 v[32:35], v[100:103], a[40:43], v[32:35]
    s_waitcnt lgkmcnt(3)
    ds_read_b128 v[92:95], v12 offset:41216
    v_mfma_f32_16x16x32_bf16 v[36:39], v[100:103], a[44:47], v[36:39]
    v_mfma_f32_16x16x32_bf16 v[24:27], v[104:107], a[40:43], v[24:27]
    ds_read_b128 v[96:99], v12 offset:14336
    v_mfma_f32_16x16x32_bf16 v[28:31], v[104:107], a[44:47], v[28:31]
    global_load_dwordx4 a[88:91], v12, s[36:37] offset:2048 sc1
    v_mfma_f32_16x16x32_bf16 v[40:43], v[108:111], a[40:43], v[40:43]
    s_waitcnt lgkmcnt(3)
    ds_read_b128 v[100:103], v12 offset:43008
    v_mfma_f32_16x16x32_bf16 v[44:47], v[108:111], a[44:47], v[44:47]
    s_waitcnt vmcnt(10)
    v_mfma_f32_16x16x32_bf16 v[16:19], v[80:83], a[48:51], v[16:19]
    ds_read_b128 v[104:107], v12 offset:14592
    s_waitcnt vmcnt(9)
    v_mfma_f32_16x16x32_bf16 v[20:23], v[80:83], a[52:55], v[20:23]
    global_load_dwordx4 a[92:95], v12, s[36:37] offset:2304 sc1
    v_mfma_f32_16x16x32_bf16 v[32:35], v[84:87], a[48:51], v[32:35]
    s_waitcnt lgkmcnt(3)
    ds_read_b128 v[108:111], v12 offset:43264
    v_mfma_f32_16x16x32_bf16 v[36:39], v[84:87], a[52:55], v[36:39]
    v_mfma_f32_16x16x32_bf16 v[24:27], v[88:91], a[48:51], v[24:27]
    ds_read_b128 v[80:83], v12 offset:16384
    v_mfma_f32_16x16x32_bf16 v[28:31], v[88:91], a[52:55], v[28:31]
    s_add_u32 s36, s36, 8192
    s_addc_u32 s37, s37, 0
    global_load_dwordx4 a[96:99], v12, s[36:37] offset:-4096 sc1
    v_mfma_f32_16x16x32_bf16 v[40:43], v[92:95], a[48:51], v[40:43]
    s_waitcnt lgkmcnt(3)
    ds_read_b128 v[84:87], v12 offset:45056
    v_mfma_f32_16x16x32_bf16 v[44:47], v[92:95], a[52:55], v[44:47]
    s_waitcnt vmcnt(10)
    v_mfma_f32_16x16x32_bf16 v[16:19], v[96:99], a[56:59], v[16:19]
    ds_read_b128 v[88:91], v12 offset:16640
    s_waitcnt vmcnt(9)
    v_mfma_f32_16x16x32_bf16 v[20:23], v[96:99], a[60:63], v[20:23]
    global_load_dwordx4 a[100:103], v12, s[36:37] offset:-3840 sc1
    v_mfma_f32_16x16x32_bf16 v[32:35], v[100:103], a[56:59], v[32:35]
    s_waitcnt lgkmcnt(3)
    ds_read_b128 v[92:95], v12 offset:45312
    v_mfma_f32_16x16x32_bf16 v[36:39], v[100:103], a[60:63], v[36:39]
    v_mfma_f32_16x16x32_bf16 v[24:27], v[104:107], a[56:59], v[24:27]
    ds_read_b128 v[96:99], v12 offset:18432
    v_mfma_f32_16x16x32_bf16 v[28:31], v[104:107], a[60:63], v[28:31]
    global_load_dwordx4 a[104:107], v12, s[36:37] offset:-2048 sc1
    v_mfma_f32_16x16x32_bf16 v[40:43], v[108:111], a[56:59], v[40:43]
    s_waitcnt lgkmcnt(3)
    ds_read_b128 v[100:103], v12 offset:47104
    v_mfma_f32_16x16x32_bf16 v[44:47], v[108:111], a[60:63], v[44:47]
    s_waitcnt vmcnt(10)
    v_mfma_f32_16x16x32_bf16 v[16:19], v[80:83], a[64:67], v[16:19]
    ds_read_b128 v[104:107], v12 offset:18688
    s_waitcnt vmcnt(9)
    v_mfma_f32_16x16x32_bf16 v[20:23], v[80:83], a[68:71], v[20:23]
    global_load_dwordx4 a[108:111], v12, s[36:37] offset:-1792 sc1
    v_mfma_f32_16x16x32_bf16 v[32:35], v[84:87], a[64:67], v[32:35]
    s_waitcnt lgkmcnt(3)
    ds_read_b128 v[108:111], v12 offset:47360
    v_mfma_f32_16x16x32_bf16 v[36:39], v[84:87], a[68:71], v[36:39]
    v_mfma_f32_16x16x32_bf16 v[24:27], v[88:91], a[64:67], v[24:27]
    ds_read_b128 v[80:83], v12 offset:20480
    v_mfma_f32_16x16x32_bf16 v[28:31], v[88:91], a[68:71], v[28:31]
    s_add_u32 s40, s40, 8192
    s_addc_u32 s41, s41, 0
    global_load_dwordx4 a[144:147], v2, s[40:41] offset:-4096 sc1
    v_mfma_f32_16x16x32_bf16 v[40:43], v[92:95], a[64:67], v[40:43]
    s_waitcnt lgkmcnt(3)
    ds_read_b128 v[84:87], v12 offset:49152
    v_mfma_f32_16x16x32_bf16 v[44:47], v[92:95], a[68:71], v[44:47]
    s_waitcnt vmcnt(10)
    v_mfma_f32_16x16x32_bf16 v[16:19], v[96:99], a[72:75], v[16:19]
    ds_read_b128 v[88:91], v12 offset:20736
    s_waitcnt vmcnt(9)
    v_mfma_f32_16x16x32_bf16 v[20:23], v[96:99], a[76:79], v[20:23]
    global_load_dwordx4 a[148:151], v3, s[40:41] offset:-4096 sc1
    v_mfma_f32_16x16x32_bf16 v[32:35], v[100:103], a[72:75], v[32:35]
    s_waitcnt lgkmcnt(3)
    ds_read_b128 v[92:95], v12 offset:49408
    v_mfma_f32_16x16x32_bf16 v[36:39], v[100:103], a[76:79], v[36:39]
    v_mfma_f32_16x16x32_bf16 v[24:27], v[104:107], a[72:75], v[24:27]
    ds_read_b128 v[96:99], v12 offset:22528
    v_mfma_f32_16x16x32_bf16 v[28:31], v[104:107], a[76:79], v[28:31]
    global_load_dwordx4 a[152:155], v7, s[40:41] offset:-4096 sc1
    v_mfma_f32_16x16x32_bf16 v[40:43], v[108:111], a[72:75], v[40:43]
    s_waitcnt lgkmcnt(3)
    ds_read_b128 v[100:103], v12 offset:51200
    v_mfma_f32_16x16x32_bf16 v[44:47], v[108:111], a[76:79], v[44:47]
    s_waitcnt vmcnt(10)
    v_mfma_f32_16x16x32_bf16 v[16:19], v[80:83], a[80:83], v[16:19]
    ds_read_b128 v[104:107], v12 offset:22784
    s_waitcnt vmcnt(9)
    v_mfma_f32_16x16x32_bf16 v[20:23], v[80:83], a[84:87], v[20:23]
    global_load_dwordx4 a[156:159], v11, s[40:41] offset:-4096 sc1
    v_mfma_f32_16x16x32_bf16 v[32:35], v[84:87], a[80:83], v[32:35]
    s_waitcnt lgkmcnt(3)
    ds_read_b128 v[108:111], v12 offset:51456
    v_mfma_f32_16x16x32_bf16 v[36:39], v[84:87], a[84:87], v[36:39]
    v_mfma_f32_16x16x32_bf16 v[24:27], v[88:91], a[80:83], v[24:27]
    ds_read_b128 v[80:83], v12 offset:24576
    v_mfma_f32_16x16x32_bf16 v[28:31], v[88:91], a[84:87], v[28:31]
    global_load_dwordx4 a[160:163], v2, s[40:41] offset:0 sc1
    v_mfma_f32_16x16x32_bf16 v[40:43], v[92:95], a[80:83], v[40:43]
    s_waitcnt lgkmcnt(3)
    ds_read_b128 v[84:87], v12 offset:53248
    v_mfma_f32_16x16x32_bf16 v[44:47], v[92:95], a[84:87], v[44:47]
    s_waitcnt vmcnt(10)
    v_mfma_f32_16x16x32_bf16 v[16:19], v[96:99], a[88:91], v[16:19]
    ds_read_b128 v[88:91], v12 offset:24832
    s_waitcnt vmcnt(9)
    v_mfma_f32_16x16x32_bf16 v[20:23], v[96:99], a[92:95], v[20:23]
    global_load_dwordx4 a[164:167], v3, s[40:41] offset:0 sc1
    v_mfma_f32_16x16x32_bf16 v[32:35], v[100:103], a[88:91], v[32:35]
    s_waitcnt lgkmcnt(3)
    ds_read_b128 v[92:95], v12 offset:53504
    v_mfma_f32_16x16x32_bf16 v[36:39], v[100:103], a[92:95], v[36:39]
    v_mfma_f32_16x16x32_bf16 v[24:27], v[104:107], a[88:91], v[24:27]
    ds_read_b128 v[96:99], v12 offset:26624
    v_mfma_f32_16x16x32_bf16 v[28:31], v[104:107], a[92:95], v[28:31]
    global_load_dwordx4 a[168:171], v7, s[40:41] offset:0 sc1
    v_mfma_f32_16x16x32_bf16 v[40:43], v[108:111], a[88:91], v[40:43]
    s_waitcnt lgkmcnt(3)
    ds_read_b128 v[100:103], v12 offset:55296
    v_mfma_f32_16x16x32_bf16 v[44:47], v[108:111], a[92:95], v[44:47]
    s_waitcnt vmcnt(10)
    v_mfma_f32_16x16x32_bf16 v[16:19], v[80:83], a[96:99], v[16:19]
    ds_read_b128 v[104:107], v12 offset:26880
    s_waitcnt vmcnt(9)
    v_mfma_f32_16x16x32_bf16 v[20:23], v[80:83], a[100:103], v[20:23]
    global_load_dwordx4 a[172:175], v11, s[40:41] offset:0 sc1
    v_mfma_f32_16x16x32_bf16 v[32:35], v[84:87], a[96:99], v[32:35]
    s_waitcnt lgkmcnt(3)
    ds_read_b128 v[108:111], v12 offset:55552
    v_mfma_f32_16x16x32_bf16 v[36:39], v[84:87], a[100:103], v[36:39]
    v_mfma_f32_16x16x32_bf16 v[24:27], v[88:91], a[96:99], v[24:27]
    ds_read_b128 v[80:83], v4 offset:0
    v_mfma_f32_16x16x32_bf16 v[28:31], v[88:91], a[100:103], v[28:31]
    s_add_u32 s40, s40, 8192
    s_addc_u32 s41, s41, 0
    global_load_dwordx4 a[176:179], v2, s[40:41] offset:-4096 sc1
    v_mfma_f32_16x16x32_bf16 v[40:43], v[92:95], a[96:99], v[40:43]
    s_waitcnt lgkmcnt(3)
    ds_read_b128 v[84:87], v4 offset:256
    v_mfma_f32_16x16x32_bf16 v[44:47], v[92:95], a[100:103], v[44:47]
    s_waitcnt vmcnt(10)
    v_mfma_f32_16x16x32_bf16 v[16:19], v[96:99], a[104:107], v[16:19]
    ds_read_b128 v[88:91], v4 offset:2048
    s_waitcnt vmcnt(9)
    v_mfma_f32_16x16x32_bf16 v[20:23], v[96:99], a[108:111], v[20:23]
    global_load_dwordx4 a[180:183], v3, s[40:41] offset:-4096 sc1
    v_mfma_f32_16x16x32_bf16 v[32:35], v[100:103], a[104:107], v[32:35]
    s_waitcnt lgkmcnt(3)
    ds_read_b128 v[92:95], v4 offset:2304
    v_mfma_f32_16x16x32_bf16 v[36:39], v[100:103], a[108:111], v[36:39]
    v_mfma_f32_16x16x32_bf16 v[24:27], v[104:107], a[104:107], v[24:27]
    ds_read_b128 v[96:99], v4 offset:4096
    v_mfma_f32_16x16x32_bf16 v[28:31], v[104:107], a[108:111], v[28:31]
    global_load_dwordx4 a[184:187], v7, s[40:41] offset:-4096 sc1
    v_mfma_f32_16x16x32_bf16 v[40:43], v[108:111], a[104:107], v[40:43]
    s_waitcnt lgkmcnt(3)
    ds_read_b128 v[100:103], v4 offset:4352
    v_mfma_f32_16x16x32_bf16 v[44:47], v[108:111], a[108:111], v[44:47]
    s_barrier
    v_mfma_f32_16x16x32_bf16 v[48:51], v[80:83], a[0:3], 0
    ds_read_b128 v[104:107], v4 offset:6144
    v_mfma_f32_16x16x32_bf16 v[52:55], v[80:83], a[4:7], 0
    s_add_u32 m0, s58, 0
    s_nop 0
    buffer_load_dwordx4 v1, s[48:51], m0 offen offset:0 sc1 lds
    v_mfma_f32_16x16x32_bf16 v[56:59], v[84:87], a[0:3], 0
    s_waitcnt lgkmcnt(3)
    ds_read_b128 v[108:111], v4 offset:6400
    v_mfma_f32_16x16x32_bf16 v[60:63], v[84:87], a[4:7], 0
    v_mfma_f32_16x16x32_bf16 v[48:51], v[88:91], a[8:11], v[48:51]
    ds_read_b128 v[80:83], v4 offset:8192
    v_mfma_f32_16x16x32_bf16 v[52:55], v[88:91], a[12:15], v[52:55]
    buffer_load_dwordx4 v1, s[48:51], m0 offen offset:1024 sc1 lds
    v_mfma_f32_16x16x32_bf16 v[56:59], v[92:95], a[8:11], v[56:59]
    s_waitcnt lgkmcnt(3)
    ds_read_b128 v[84:87], v4 offset:8448
    v_fma_f32 v112, v16, v16, v9
    v_fma_f32 v113, v17, v17, v9
    v_fma_f32 v114, v18, v18, v9
    v_mfma_f32_16x16x32_bf16 v[60:63], v[92:95], a[12:15], v[60:63]
    v_fma_f32 v115, v19, v19, v9
    v_mul_f32 v112, v16, v112
    v_mfma_f32_16x16x32_bf16 v[48:51], v[96:99], a[16:19], v[48:51]
    ds_read_b128 v[88:91], v4 offset:10240
    v_mul_f32 v113, v17, v113
    v_mul_f32 v114, v18, v114
    v_mfma_f32_16x16x32_bf16 v[52:55], v[96:99], a[20:23], v[52:55]
    buffer_load_dwordx4 v1, s[48:51], m0 offen offset:2048 sc1 lds
    v_mul_f32 v115, v19, v115
    v_exp_f32 v112, v112
    v_mfma_f32_16x16x32_bf16 v[56:59], v[100:103], a[16:19], v[56:59]
    s_waitcnt lgkmcnt(3)
    ds_read_b128 v[92:95], v4 offset:10496
    v_mul_f32 v116, v16, v24
    v_mfma_f32_16x16x32_bf16 v[60:63], v[100:103], a[20:23], v[60:63]
    v_exp_f32 v113, v113
    v_mfma_f32_16x16x32_bf16 v[48:51], v[104:107], a[24:27], v[48:51]
    ds_read_b128 v[96:99], v4 offset:12288
    v_mul_f32 v117, v17, v25
    v_exp_f32 v114, v114
    v_mfma_f32_16x16x32_bf16 v[52:55], v[104:107], a[28:31], v[52:55]
    s_add_u32 m0, s58, 3072
    s_nop 0
    buffer_load_dwordx4 v1, s[48:51], m0 offen offset:0 sc1 lds
    v_mul_f32 v118, v18, v26
    v_mfma_f32_16x16x32_bf16 v[56:59], v[108:111], a[24:27], v[56:59]
    s_waitcnt lgkmcnt(3)
    ds_read_b128 v[100:103], v4 offset:12544
    v_exp_f32 v115, v115
    v_mfma_f32_16x16x32_bf16 v[60:63], v[108:111], a[28:31], v[60:63]
    v_mul_f32 v119, v19, v27
    v_fma_f32 v112, v112, v8, v8
    v_mfma_f32_16x16x32_bf16 v[48:51], v[80:83], a[32:35], v[48:51]
    ds_read_b128 v[104:107], v4 offset:14336
    v_fma_f32 v113, v113, v8, v8
    v_fma_f32 v114, v114, v8, v8
    v_fma_f32 v115, v115, v8, v8
    v_mfma_f32_16x16x32_bf16 v[52:55], v[80:83], a[36:39], v[52:55]
    buffer_load_dwordx4 v1, s[48:51], m0 offen offset:1024 sc1 lds
    v_rcp_f32 v112, v112
    v_mfma_f32_16x16x32_bf16 v[56:59], v[84:87], a[32:35], v[56:59]
    s_waitcnt lgkmcnt(3)
    ds_read_b128 v[108:111], v4 offset:14592
    v_rcp_f32 v113, v113
    v_mfma_f32_16x16x32_bf16 v[60:63], v[84:87], a[36:39], v[60:63]
    v_rcp_f32 v114, v114
    v_mfma_f32_16x16x32_bf16 v[48:51], v[88:91], a[40:43], v[48:51]
    ds_read_b128 v[80:83], v4 offset:16384
    v_rcp_f32 v115, v115
    v_mfma_f32_16x16x32_bf16 v[52:55], v[88:91], a[44:47], v[52:55]
    buffer_load_dwordx4 v1, s[48:51], m0 offen offset:2048 sc1 lds
    v_mul_f32 v116, v116, v112
    v_mfma_f32_16x16x32_bf16 v[56:59], v[92:95], a[40:43], v[56:59]
    s_waitcnt lgkmcnt(3)
    ds_read_b128 v[84:87], v4 offset:16640
    v_mul_f32 v117, v117, v113
    v_mul_f32 v118, v118, v114
    v_mfma_f32_16x16x32_bf16 v[60:63], v[92:95], a[44:47], v[60:63]
    v_mul_f32 v119, v119, v115
    v_cvt_pk_bf16_f32 v144, v116, v117
    v_cvt_pk_bf16_f32 v145, v118, v119
    v_mfma_f32_16x16x32_bf16 v[48:51], v[96:99], a[48:51], v[48:51]
    ds_read_b128 v[88:91], v4 offset:18432
    v_fma_f32 v112, v20, v20, v9
    v_fma_f32 v113, v21, v21, v9
    v_mfma_f32_16x16x32_bf16 v[52:55], v[96:99], a[52:55], v[52:55]
    buffer_load_dwordx4 v1, s[48:51], m0 offen offset:3072 sc1 lds
    v_fma_f32 v114, v22, v22, v9
    v_mfma_f32_16x16x32_bf16 v[56:59], v[100:103], a[48:51], v[56:59]
    s_waitcnt lgkmcnt(3)
    ds_read_b128 v[92:95], v4 offset:18688
    v_fma_f32 v115, v23, v23, v9
    v_mul_f32 v112, v20, v112
    v_mul_f32 v113, v21, v113
    v_mfma_f32_16x16x32_bf16 v[60:63], v[100:103], a[52:55], v[60:63]
    v_mul_f32 v114, v22, v114
    v_mul_f32 v115, v23, v115
    v_mfma_f32_16x16x32_bf16 v[48:51], v[104:107], a[56:59], v[48:51]
    ds_read_b128 v[96:99], v4 offset:20480
    v_exp_f32 v112, v112
    v_mfma_f32_16x16x32_bf16 v[52:55], v[104:107], a[60:63], v[52:55]
    s_add_u32 m0, s58, 28672
    s_nop 0
    buffer_load_dwordx4 v1, s[48:51], m0 offen offset:0 sc1 lds
    v_mul_f32 v116, v20, v28
    v_exp_f32 v113, v113
    v_mfma_f32_16x16x32_bf16 v[56:59], v[108:111], a[56:59], v[56:59]
    s_waitcnt lgkmcnt(3)
    ds_read_b128 v[100:103], v4 offset:20736
    v_mul_f32 v117, v21, v29
    v_mfma_f32_16x16x32_bf16 v[60:63], v[108:111], a[60:63], v[60:63]
    v_exp_f32 v114, v114
    v_mfma_f32_16x16x32_bf16 v[48:51], v[80:83], a[64:67], v[48:51]
    ds_read_b128 v[104:107], v4 offset:22528
    v_mul_f32 v118, v22, v30
    v_exp_f32 v115, v115
    v_mfma_f32_16x16x32_bf16 v[52:55], v[80:83], a[68:71], v[52:55]
    buffer_load_dwordx4 v1, s[48:51], m0 offen offset:1024 sc1 lds
    v_mul_f32 v119, v23, v31
    v_mfma_f32_16x16x32_bf16 v[56:59], v[84:87], a[64:67], v[56:59]
    s_waitcnt lgkmcnt(3)
    ds_read_b128 v[108:111], v4 offset:22784
    v_fma_f32 v112, v112, v8, v8
    v_fma_f32 v113, v113, v8, v8
    v_mfma_f32_16x16x32_bf16 v[60:63], v[84:87], a[68:71], v[60:63]
    v_fma_f32 v114, v114, v8, v8
    v_fma_f32 v115, v115, v8, v8
    v_mfma_f32_16x16x32_bf16 v[48:51], v[88:91], a[72:75], v[48:51]
    ds_read_b128 v[80:83], v4 offset:24576
    v_rcp_f32 v112, v112
    v_rcp_f32 v113, v113
    v_mfma_f32_16x16x32_bf16 v[52:55], v[88:91], a[76:79], v[52:55]
    buffer_load_dwordx4 v1, s[48:51], m0 offen offset:2048 sc1 lds
    v_mfma_f32_16x16x32_bf16 v[56:59], v[92:95], a[72:75], v[56:59]
    s_waitcnt lgkmcnt(3)
    ds_read_b128 v[84:87], v4 offset:24832
    v_rcp_f32 v114, v114
    v_mfma_f32_16x16x32_bf16 v[60:63], v[92:95], a[76:79], v[60:63]
    v_rcp_f32 v115, v115
    v_mul_f32 v116, v116, v112
    v_mfma_f32_16x16x32_bf16 v[48:51], v[96:99], a[80:83], v[48:51]
    ds_read_b128 v[88:91], v4 offset:26624
    v_mul_f32 v117, v117, v113
    v_mul_f32 v118, v118, v114
    v_mfma_f32_16x16x32_bf16 v[52:55], v[96:99], a[84:87], v[52:55]
    s_add_u32 m0, s58, 31744
    s_nop 0
    buffer_load_dwordx4 v1, s[48:51], m0 offen offset:0 sc1 lds
    v_mul_f32 v119, v119, v115
    v_mfma_f32_16x16x32_bf16 v[56:59], v[100:103], a[80:83], v[56:59]
    s_waitcnt lgkmcnt(3)
    ds_read_b128 v[92:95], v4 offset:26880
    v_cvt_pk_bf16_f32 v146, v116, v117
    v_cvt_pk_bf16_f32 v147, v118, v119
    v_mfma_f32_16x16x32_bf16 v[60:63], v[100:103], a[84:87], v[60:63]
    v_permlane32_swap_b32 v144, v146
    v_permlane32_swap_b32 v145, v147
    global_store_dwordx4 v13, v[144:147], s[38:39] offset:-4096 sc1
    v_mfma_f32_16x16x32_bf16 v[48:51], v[104:107], a[88:91], v[48:51]
    ds_read_b128 v[96:99], v4 offset:28672
    v_fma_f32 v112, v32, v32, v9
    v_mfma_f32_16x16x32_bf16 v[52:55], v[104:107], a[92:95], v[52:55]
    v_fma_f32 v113, v33, v33, v9
    v_fma_f32 v114, v34, v34, v9
    v_mfma_f32_16x16x32_bf16 v[56:59], v[108:111], a[88:91], v[56:59]
    s_waitcnt lgkmcnt(3)
    ds_read_b128 v[100:103], v4 offset:28928
    v_fma_f32 v115, v35, v35, v9
    v_mul_f32 v112, v32, v112
    v_mul_f32 v113, v33, v113
    v_mfma_f32_16x16x32_bf16 v[60:63], v[108:111], a[92:95], v[60:63]
    v_mul_f32 v114, v34, v114
    v_mul_f32 v115, v35, v115
    v_mfma_f32_16x16x32_bf16 v[48:51], v[80:83], a[96:99], v[48:51]
    ds_read_b128 v[104:107], v4 offset:30720
    v_exp_f32 v112, v112
    v_mfma_f32_16x16x32_bf16 v[52:55], v[80:83], a[100:103], v[52:55]
    v_mul_f32 v116, v32, v40
    v_exp_f32 v113, v113
    v_mfma_f32_16x16x32_bf16 v[56:59], v[84:87], a[96:99], v[56:59]
    s_waitcnt lgkmcnt(3)
    ds_read_b128 v[108:111], v4 offset:30976
    v_mul_f32 v117, v33, v41
    v_exp_f32 v114, v114
    v_mfma_f32_16x16x32_bf16 v[60:63], v[84:87], a[100:103], v[60:63]
    buffer_load_dwordx4 v1, s[48:51], m0 offen offset:1024 sc1 lds
    v_mfma_f32_16x16x32_bf16 v[48:51], v[88:91], a[104:107], v[48:51]
    ds_read_b128 v[80:83], v4 offset:32768
    v_mul_f32 v118, v34, v42
    v_exp_f32 v115, v115
    v_mfma_f32_16x16x32_bf16 v[52:55], v[88:91], a[108:111], v[52:55]
    v_mul_f32 v119, v35, v43
    v_fma_f32 v112, v112, v8, v8
    v_mfma_f32_16x16x32_bf16 v[56:59], v[92:95], a[104:107], v[56:59]
    s_waitcnt lgkmcnt(3)
    ds_read_b128 v[84:87], v4 offset:33024
    v_fma_f32 v113, v113, v8, v8
    v_fma_f32 v114, v114, v8, v8
    v_mfma_f32_16x16x32_bf16 v[60:63], v[92:95], a[108:111], v[60:63]
    buffer_load_dwordx4 v1, s[48:51], m0 offen offset:2048 sc1 lds
    v_fma_f32 v115, v115, v8, v8
    v_mfma_f32_16x16x32_bf16 v[64:67], v[96:99], a[0:3], 0
    ds_read_b128 v[88:91], v4 offset:34816
    v_rcp_f32 v112, v112
    v_rcp_f32 v113, v113
    v_mfma_f32_16x16x32_bf16 v[68:71], v[96:99], a[4:7], 0
    v_rcp_f32 v114, v114
    v_mfma_f32_16x16x32_bf16 v[72:75], v[100:103], a[0:3], 0
    s_waitcnt lgkmcnt(3)
    ds_read_b128 v[92:95], v4 offset:35072
    v_rcp_f32 v115, v115
    v_mfma_f32_16x16x32_bf16 v[76:79], v[100:103], a[4:7], 0
    buffer_load_dwordx4 v1, s[48:51], m0 offen offset:3072 sc1 lds
    v_mul_f32 v116, v116, v112
    v_mfma_f32_16x16x32_bf16 v[64:67], v[104:107], a[8:11], v[64:67]
    ds_read_b128 v[96:99], v4 offset:36864
    v_mul_f32 v117, v117, v113
    v_mul_f32 v118, v118, v114
    v_mfma_f32_16x16x32_bf16 v[68:71], v[104:107], a[12:15], v[68:71]
    v_mul_f32 v119, v119, v115
    v_cvt_pk_bf16_f32 v148, v116, v117
    v_mfma_f32_16x16x32_bf16 v[72:75], v[108:111], a[8:11], v[72:75]
    s_waitcnt lgkmcnt(3)
    ds_read_b128 v[100:103], v4 offset:37120
    v_cvt_pk_bf16_f32 v149, v118, v119
    v_fma_f32 v112, v36, v36, v9
    v_mfma_f32_16x16x32_bf16 v[76:79], v[108:111], a[12:15], v[76:79]
L_pad4:
    s_cbranch_execz L_back1
    global_load_dwordx4 a[188:191], v11, s[40:41] offset:-4096 sc1
    v_fma_f32 v113, v37, v37, v9
    v_fma_f32 v114, v38, v38, v9
    v_mfma_f32_16x16x32_bf16 v[64:67], v[80:83], a[16:19], v[64:67]
    ds_read_b128 v[104:107], v4 offset:38912
    v_fma_f32 v115, v39, v39, v9
    v_mul_f32 v112, v36, v112
    v_mfma_f32_16x16x32_bf16 v[68:71], v[80:83], a[20:23], v[68:71]
    v_mul_f32 v113, v37, v113
    v_mul_f32 v114, v38, v114
    v_mfma_f32_16x16x32_bf16 v[72:75], v[84:87], a[16:19], v[72:75]
    s_waitcnt lgkmcnt(3)
    ds_read_b128 v[108:111], v4 offset:39168
    v_mul_f32 v115, v39, v115
    v_exp_f32 v112, v112
    v_mfma_f32_16x16x32_bf16 v[76:79], v[84:87], a[20:23], v[76:79]
    global_load_dwordx4 a[192:195], v2, s[40:41] offset:0 sc1
    v_mul_f32 v116, v36, v44
    v_mfma_f32_16x16x32_bf16 v[64:67], v[88:91], a[24:27], v[64:67]
    ds_read_b128 v[80:83], v4 offset:40960
    v_exp_f32 v113, v113
    v_mfma_f32_16x16x32_bf16 v[68:71], v[88:91], a[28:31], v[68:71]
    v_mul_f32 v117, v37, v45
    v_exp_f32 v114, v114
    v_mfma_f32_16x16x32_bf16 v[72:75], v[92:95], a[24:27], v[72:75]
    s_waitcnt lgkmcnt(3)
    ds_read_b128 v[84:87], v4 offset:41216
    v_mul_f32 v118, v38, v46
    v_exp_f32 v115, v115
    v_mfma_f32_16x16x32_bf16 v[76:79], v[92:95], a[28:31], v[76:79]
    global_load_dwordx4 a[196:199], v3, s[40:41] offset:0 sc1
    v_mfma_f32_16x16x32_bf16 v[64:67], v[96:99], a[32:35], v[64:67]
    ds_read_b128 v[88:91], v4 offset:43008
    v_mul_f32 v119, v39, v47
    v_fma_f32 v112, v112, v8, v8
    v_mfma_f32_16x16x32_bf16 v[68:71], v[96:99], a[36:39], v[68:71]
    v_fma_f32 v113, v113, v8, v8
    v_fma_f32 v114, v114, v8, v8
    v_fma_f32 v115, v115, v8, v8
    v_mfma_f32_16x16x32_bf16 v[72:75], v[100:103], a[32:35], v[72:75]
    s_waitcnt lgkmcnt(3)
    ds_read_b128 v[92:95], v4 offset:43264
    v_rcp_f32 v112, v112
    v_mfma_f32_16x16x32_bf16 v[76:79], v[100:103], a[36:39], v[76:79]
    global_load_dwordx4 a[200:203], v7, s[40:41] offset:0 sc1
    v_rcp_f32 v113, v113
    v_mfma_f32_16x16x32_bf16 v[64:67], v[104:107], a[40:43], v[64:67]
    ds_read_b128 v[96:99], v4 offset:45056
    v_rcp_f32 v114, v114
    v_mfma_f32_16x16x32_bf16 v[68:71], v[104:107], a[44:47], v[68:71]
    v_rcp_f32 v115, v115
    v_mfma_f32_16x16x32_bf16 v[72:75], v[108:111], a[40:43], v[72:75]
    s_waitcnt lgkmcnt(3)
    ds_read_b128 v[100:103], v4 offset:45312
    v_mul_f32 v116, v116, v112
    v_mul_f32 v117, v117, v113
    v_mfma_f32_16x16x32_bf16 v[76:79], v[108:111], a[44:47], v[76:79]
    global_load_dwordx4 a[204:207], v11, s[40:41] offset:0 sc1
    v_mul_f32 v118, v118, v114
    v_mul_f32 v119, v119, v115
    v_mfma_f32_16x16x32_bf16 v[64:67], v[80:83], a[48:51], v[64:67]
    ds_read_b128 v[104:107], v4 offset:47104
    v_cvt_pk_bf16_f32 v150, v116, v117
    v_cvt_pk_bf16_f32 v151, v118, v119
    v_mfma_f32_16x16x32_bf16 v[68:71], v[80:83], a[52:55], v[68:71]
    v_permlane32_swap_b32 v148, v150
    v_permlane32_swap_b32 v149, v151
    v_mfma_f32_16x16x32_bf16 v[72:75], v[84:87], a[48:51], v[72:75]
    s_waitcnt lgkmcnt(3)
    ds_read_b128 v[108:111], v4 offset:47360
    global_store_dwordx4 v13, v[148:151], s[38:39] offset:0 sc1
    v_mfma_f32_16x16x32_bf16 v[76:79], v[84:87], a[52:55], v[76:79]
    v_fma_f32 v112, v48, v48, v9
    v_fma_f32 v113, v49, v49, v9
    v_fma_f32 v114, v50, v50, v9
    v_mfma_f32_16x16x32_bf16 v[64:67], v[88:91], a[56:59], v[64:67]
    ds_read_b128 v[80:83], v4 offset:49152
    v_fma_f32 v115, v51, v51, v9
    v_mul_f32 v112, v48, v112
    v_mfma_f32_16x16x32_bf16 v[68:71], v[88:91], a[60:63], v[68:71]
    v_mul_f32 v113, v49, v113
    v_mul_f32 v114, v50, v114
    v_mfma_f32_16x16x32_bf16 v[72:75], v[92:95], a[56:59], v[72:75]
    s_waitcnt lgkmcnt(3)
    ds_read_b128 v[84:87], v4 offset:49408
    v_mul_f32 v115, v51, v115
    v_exp_f32 v112, v112
    v_mfma_f32_16x16x32_bf16 v[76:79], v[92:95], a[60:63], v[76:79]
    v_mul_f32 v116, v48, v56
    v_exp_f32 v113, v113
    v_mfma_f32_16x16x32_bf16 v[64:67], v[96:99], a[64:67], v[64:67]
    ds_read_b128 v[88:91], v4 offset:51200
    v_mul_f32 v117, v49, v57
    v_mfma_f32_16x16x32_bf16 v[68:71], v[96:99], a[68:71], v[68:71]
    s_add_u32 s40, s40, 8192
    s_addc_u32 s41, s41, 0
    global_load_dwordx4 a[208:211], v2, s[40:41] offset:-4096 sc1
    v_exp_f32 v114, v114
    v_mfma_f32_16x16x32_bf16 v[72:75], v[100:103], a[64:67], v[72:75]
    s_waitcnt lgkmcnt(3)
    ds_read_b128 v[92:95], v4 offset:51456
    v_mul_f32 v118, v50, v58
    v_exp_f32 v115, v115
    v_mfma_f32_16x16x32_bf16 v[76:79], v[100:103], a[68:71], v[76:79]
    v_mul_f32 v119, v51, v59
    v_mfma_f32_16x16x32_bf16 v[64:67], v[104:107], a[72:75], v[64:67]
    ds_read_b128 v[96:99], v4 offset:53248
    v_fma_f32 v112, v112, v8, v8
    v_fma_f32 v113, v113, v8, v8
    v_mfma_f32_16x16x32_bf16 v[68:71], v[104:107], a[76:79], v[68:71]
    global_load_dwordx4 a[212:215], v3, s[40:41] offset:-4096 sc1
    v_fma_f32 v114, v114, v8, v8
    v_fma_f32 v115, v115, v8, v8
    v_mfma_f32_16x16x32_bf16 v[72:75], v[108:111], a[72:75], v[72:75]
    s_waitcnt lgkmcnt(3)
    ds_read_b128 v[100:103], v4 offset:53504
    v_rcp_f32 v112, v112
    v_mfma_f32_16x16x32_bf16 v[76:79], v[108:111], a[76:79], v[76:79]
    v_rcp_f32 v113, v113
    v_mfma_f32_16x16x32_bf16 v[64:67], v[80:83], a[80:83], v[64:67]
    ds_read_b128 v[104:107], v4 offset:55296
    v_rcp_f32 v114, v114
    v_rcp_f32 v115, v115
    v_mfma_f32_16x16x32_bf16 v[68:71], v[80:83], a[84:87], v[68:71]
    global_load_dwordx4 a[216:219], v7, s[40:41] offset:-4096 sc1
    v_mfma_f32_16x16x32_bf16 v[72:75], v[84:87], a[80:83], v[72:75]
    s_waitcnt lgkmcnt(3)
    ds_read_b128 v[108:111], v4 offset:55552
    v_mul_f32 v116, v116, v112
    v_mul_f32 v117, v117, v113
    v_mfma_f32_16x16x32_bf16 v[76:79], v[84:87], a[84:87], v[76:79]
    v_mul_f32 v118, v118, v114
    v_mul_f32 v119, v119, v115
    v_cvt_pk_bf16_f32 v152, v116, v117
    v_mfma_f32_16x16x32_bf16 v[64:67], v[88:91], a[88:91], v[64:67]
    ds_read_b128 v[80:83], v5 offset:0
    v_cvt_pk_bf16_f32 v153, v118, v119
    v_fma_f32 v112, v52, v52, v9
    v_mfma_f32_16x16x32_bf16 v[68:71], v[88:91], a[92:95], v[68:71]
    global_load_dwordx4 a[220:223], v11, s[40:41] offset:-4096 sc1
    v_fma_f32 v113, v53, v53, v9
    v_mfma_f32_16x16x32_bf16 v[72:75], v[92:95], a[88:91], v[72:75]
    s_waitcnt lgkmcnt(3)
    ds_read_b128 v[84:87], v5 offset:256
    v_fma_f32 v114, v54, v54, v9
    v_fma_f32 v115, v55, v55, v9
    v_mfma_f32_16x16x32_bf16 v[76:79], v[92:95], a[92:95], v[76:79]
    v_mul_f32 v112, v52, v112
    v_mul_f32 v113, v53, v113
    v_mul_f32 v114, v54, v114
    v_mfma_f32_16x16x32_bf16 v[64:67], v[96:99], a[96:99], v[64:67]
    ds_read_b128 v[88:91], v5 offset:2048
    v_mul_f32 v115, v55, v115
    v_exp_f32 v112, v112
    v_mfma_f32_16x16x32_bf16 v[68:71], v[96:99], a[100:103], v[68:71]
    global_load_dwordx4 a[224:227], v2, s[40:41] offset:0 sc1
    v_mfma_f32_16x16x32_bf16 v[72:75], v[100:103], a[96:99], v[72:75]
    s_waitcnt lgkmcnt(3)
    ds_read_b128 v[92:95], v5 offset:2304
    v_mul_f32 v116, v52, v60
    v_exp_f32 v113, v113
    v_mfma_f32_16x16x32_bf16 v[76:79], v[100:103], a[100:103], v[76:79]
    v_mul_f32 v117, v53, v61
    v_exp_f32 v114, v114
    v_mfma_f32_16x16x32_bf16 v[64:67], v[104:107], a[104:107], v[64:67]
    ds_read_b128 v[96:99], v5 offset:4096
    v_mul_f32 v118, v54, v62
    v_mfma_f32_16x16x32_bf16 v[68:71], v[104:107], a[108:111], v[68:71]
    global_load_dwordx4 a[228:231], v3, s[40:41] offset:0 sc1
    v_exp_f32 v115, v115
    v_mfma_f32_16x16x32_bf16 v[72:75], v[108:111], a[104:107], v[72:75]
    s_waitcnt lgkmcnt(3)
    ds_read_b128 v[100:103], v5 offset:4352
    v_mul_f32 v119, v55, v63
    v_fma_f32 v112, v112, v8, v8
    v_mfma_f32_16x16x32_bf16 v[76:79], v[108:111], a[108:111], v[76:79]
    v_fma_f32 v113, v113, v8, v8
    v_fma_f32 v114, v114, v8, v8
    v_mfma_f32_16x16x32_bf16 v[16:19], v[80:83], a[0:3], 0
    ds_read_b128 v[104:107], v5 offset:6144
    v_fma_f32 v115, v115, v8, v8
    v_rcp_f32 v112, v112
    v_mfma_f32_16x16x32_bf16 v[20:23], v[80:83], a[4:7], 0
    global_load_dwordx4 a[232:235], v7, s[40:41] offset:0 sc1
    v_rcp_f32 v113, v113
    v_mfma_f32_16x16x32_bf16 v[24:27], v[84:87], a[0:3], 0
    s_waitcnt lgkmcnt(3)
    ds_read_b128 v[108:111], v5 offset:6400
    v_rcp_f32 v114, v114
    v_mfma_f32_16x16x32_bf16 v[28:31], v[84:87], a[4:7], 0
    v_rcp_f32 v115, v115
    v_mfma_f32_16x16x32_bf16 v[16:19], v[88:91], a[8:11], v[16:19]
    ds_read_b128 v[80:83], v5 offset:8192
    v_mul_f32 v116, v116, v112
    v_mul_f32 v117, v117, v113
    v_mfma_f32_16x16x32_bf16 v[20:23], v[88:91], a[12:15], v[20:23]
    global_load_dwordx4 a[236:239], v11, s[40:41] offset:0 sc1
    v_mul_f32 v118, v118, v114
    v_mfma_f32_16x16x32_bf16 v[24:27], v[92:95], a[8:11], v[24:27]
    s_waitcnt lgkmcnt(3)
    ds_read_b128 v[84:87], v5 offset:8448
    v_mul_f32 v119, v119, v115
    v_cvt_pk_bf16_f32 v154, v116, v117
    v_mfma_f32_16x16x32_bf16 v[28:31], v[92:95], a[12:15], v[28:31]
    v_cvt_pk_bf16_f32 v155, v118, v119
    v_permlane32_swap_b32 v152, v154
    s_nop 0
    v_permlane32_swap_b32 v153, v155
    v_mfma_f32_16x16x32_bf16 v[16:19], v[96:99], a[16:19], v[16:19]
    ds_read_b128 v[88:91], v5 offset:10240
    s_add_u32 s38, s38, 8192
    s_addc_u32 s39, s39, 0
    global_store_dwordx4 v13, v[152:155], s[38:39] offset:-4096 sc1
    v_mfma_f32_16x16x32_bf16 v[20:23], v[96:99], a[20:23], v[20:23]
    v_fma_f32 v112, v64, v64, v9
    v_fma_f32 v113, v65, v65, v9
    v_mfma_f32_16x16x32_bf16 v[24:27], v[100:103], a[16:19], v[24:27]
    s_waitcnt lgkmcnt(3)
    ds_read_b128 v[92:95], v5 offset:10496
    v_fma_f32 v114, v66, v66, v9
    v_fma_f32 v115, v67, v67, v9
    v_mfma_f32_16x16x32_bf16 v[28:31], v[100:103], a[20:23], v[28:31]
    v_mul_f32 v112, v64, v112
    v_mul_f32 v113, v65, v113
    v_mul_f32 v114, v66, v114
    v_mfma_f32_16x16x32_bf16 v[16:19], v[104:107], a[24:27], v[16:19]
    ds_read_b128 v[96:99], v5 offset:12288
    v_mul_f32 v115, v67, v115
    v_exp_f32 v112, v112
    v_mfma_f32_16x16x32_bf16 v[20:23], v[104:107], a[28:31], v[20:23]
    v_mul_f32 v116, v64, v72
    v_mfma_f32_16x16x32_bf16 v[24:27], v[108:111], a[24:27], v[24:27]
    s_waitcnt lgkmcnt(3)
    ds_read_b128 v[100:103], v5 offset:12544
    v_exp_f32 v113, v113
    v_mul_f32 v117, v65, v73
    v_mfma_f32_16x16x32_bf16 v[28:31], v[108:111], a[28:31], v[28:31]
    s_add_u32 s40, s40, 8192
    s_addc_u32 s41, s41, 0
    global_load_dwordx4 a[240:243], v2, s[40:41] offset:-4096 sc1
    v_exp_f32 v114, v114
    v_mfma_f32_16x16x32_bf16 v[16:19], v[80:83], a[32:35], v[16:19]
    ds_read_b128 v[104:107], v5 offset:14336
    v_mul_f32 v118, v66, v74
    v_mfma_f32_16x16x32_bf16 v[20:23], v[80:83], a[36:39], v[20:23]
    v_exp_f32 v115, v115
    v_mul_f32 v119, v67, v75
    v_mfma_f32_16x16x32_bf16 v[24:27], v[84:87], a[32:35], v[24:27]
    s_waitcnt lgkmcnt(3)
    ds_read_b128 v[108:111], v5 offset:14592
    v_fma_f32 v112, v112, v8, v8
    v_fma_f32 v113, v113, v8, v8
    v_mfma_f32_16x16x32_bf16 v[28:31], v[84:87], a[36:39], v[28:31]
    global_load_dwordx4 a[244:247], v3, s[40:41] offset:-4096 sc1
    v_fma_f32 v114, v114, v8, v8
    v_mfma_f32_16x16x32_bf16 v[16:19], v[88:91], a[40:43], v[16:19]
    ds_read_b128 v[80:83], v5 offset:16384
    v_fma_f32 v115, v115, v8, v8
    v_rcp_f32 v112, v112
    v_mfma_f32_16x16x32_bf16 v[20:23], v[88:91], a[44:47], v[20:23]
    v_rcp_f32 v113, v113
    v_mfma_f32_16x16x32_bf16 v[24:27], v[92:95], a[40:43], v[24:27]
    s_waitcnt lgkmcnt(3)
    ds_read_b128 v[84:87], v5 offset:16640
    v_rcp_f32 v114, v114
    v_mfma_f32_16x16x32_bf16 v[28:31], v[92:95], a[44:47], v[28:31]
    global_load_dwordx4 a[248:251], v7, s[40:41] offset:-4096 sc1
    v_rcp_f32 v115, v115
    v_mfma_f32_16x16x32_bf16 v[16:19], v[96:99], a[48:51], v[16:19]
    ds_read_b128 v[88:91], v5 offset:18432
    v_mul_f32 v116, v116, v112
    v_mul_f32 v117, v117, v113
    v_mfma_f32_16x16x32_bf16 v[20:23], v[96:99], a[52:55], v[20:23]
    v_mul_f32 v118, v118, v114
    v_mul_f32 v119, v119, v115
    v_mfma_f32_16x16x32_bf16 v[24:27], v[100:103], a[48:51], v[24:27]
    s_waitcnt lgkmcnt(3)
    ds_read_b128 v[92:95], v5 offset:18688
    v_cvt_pk_bf16_f32 v156, v116, v117
    v_cvt_pk_bf16_f32 v157, v118, v119
    v_mfma_f32_16x16x32_bf16 v[28:31], v[100:103], a[52:55], v[28:31]
    global_load_dwordx4 a[252:255], v11, s[40:41] offset:-4096 sc1
    v_fma_f32 v112, v68, v68, v9
    v_fma_f32 v113, v69, v69, v9
    v_mfma_f32_16x16x32_bf16 v[16:19], v[104:107], a[56:59], v[16:19]
    ds_read_b128 v[96:99], v5 offset:20480
    v_fma_f32 v114, v70, v70, v9
    v_fma_f32 v115, v71, v71, v9
    v_mfma_f32_16x16x32_bf16 v[20:23], v[104:107], a[60:63], v[20:23]
    v_mul_f32 v112, v68, v112
    v_mul_f32 v113, v69, v113
    v_mfma_f32_16x16x32_bf16 v[24:27], v[108:111], a[56:59], v[24:27]
    s_waitcnt lgkmcnt(3)
    ds_read_b128 v[100:103], v5 offset:20736
    v_mul_f32 v114, v70, v114
    v_mul_f32 v115, v71, v115
    v_mfma_f32_16x16x32_bf16 v[28:31], v[108:111], a[60:63], v[28:31]
    global_load_dwordx4 v[176:179], v2, s[40:41] offset:0 sc1
    v_exp_f32 v112, v112
    v_mfma_f32_16x16x32_bf16 v[16:19], v[80:83], a[64:67], v[16:19]
    ds_read_b128 v[104:107], v5 offset:22528
    v_mul_f32 v116, v68, v76
    v_exp_f32 v113, v113
    v_mfma_f32_16x16x32_bf16 v[20:23], v[80:83], a[68:71], v[20:23]
    v_mul_f32 v117, v69, v77
    v_mfma_f32_16x16x32_bf16 v[24:27], v[84:87], a[64:67], v[24:27]
    s_waitcnt lgkmcnt(3)
    ds_read_b128 v[108:111], v5 offset:22784
    v_exp_f32 v114, v114
    v_mul_f32 v118, v70, v78
    v_mfma_f32_16x16x32_bf16 v[28:31], v[84:87], a[68:71], v[28:31]
    global_load_dwordx4 v[180:183], v3, s[40:41] offset:0 sc1
    v_exp_f32 v115, v115
    v_mfma_f32_16x16x32_bf16 v[16:19], v[88:91], a[72:75], v[16:19]
    ds_read_b128 v[80:83], v5 offset:24576
    v_mul_f32 v119, v71, v79
    v_mfma_f32_16x16x32_bf16 v[20:23], v[88:91], a[76:79], v[20:23]
    v_fma_f32 v112, v112, v8, v8
    v_fma_f32 v113, v113, v8, v8
    v_fma_f32 v114, v114, v8, v8
    v_mfma_f32_16x16x32_bf16 v[24:27], v[92:95], a[72:75], v[24:27]
    s_waitcnt lgkmcnt(3)
    ds_read_b128 v[84:87], v5 offset:24832
    v_fma_f32 v115, v115, v8, v8
    v_rcp_f32 v112, v112
    v_mfma_f32_16x16x32_bf16 v[28:31], v[92:95], a[76:79], v[28:31]
    global_load_dwordx4 v[184:187], v7, s[40:41] offset:0 sc1
    v_mfma_f32_16x16x32_bf16 v[16:19], v[96:99], a[80:83], v[16:19]
    ds_read_b128 v[88:91], v5 offset:26624
    v_rcp_f32 v113, v113
    v_mfma_f32_16x16x32_bf16 v[20:23], v[96:99], a[84:87], v[20:23]
    v_rcp_f32 v114, v114
    v_rcp_f32 v115, v115
    v_mfma_f32_16x16x32_bf16 v[24:27], v[100:103], a[80:83], v[24:27]
    s_waitcnt lgkmcnt(3)
    ds_read_b128 v[92:95], v5 offset:26880
    v_mul_f32 v116, v116, v112
    v_mfma_f32_16x16x32_bf16 v[28:31], v[100:103], a[84:87], v[28:31]
    global_load_dwordx4 v[188:191], v11, s[40:41] offset:0 sc1
    v_mul_f32 v117, v117, v113
    s_waitcnt vmcnt(23)
    s_barrier
    v_mfma_f32_16x16x32_bf16 v[16:19], v[104:107], a[88:91], v[16:19]
    ds_read_b128 v[96:99], v12 offset:0
    v_mul_f32 v118, v118, v114
    v_mul_f32 v119, v119, v115
    v_cvt_pk_bf16_f32 v158, v116, v117
    v_mfma_f32_16x16x32_bf16 v[20:23], v[104:107], a[92:95], v[20:23]
    v_cvt_pk_bf16_f32 v159, v118, v119
    v_permlane32_swap_b32 v156, v158
    v_mfma_f32_16x16x32_bf16 v[24:27], v[108:111], a[88:91], v[24:27]
    s_waitcnt lgkmcnt(3)
    ds_read_b128 v[100:103], v12 offset:256
    v_permlane32_swap_b32 v157, v159
    global_store_dwordx4 v13, v[156:159], s[38:39] offset:0 sc1
    v_mfma_f32_16x16x32_bf16 v[28:31], v[108:111], a[92:95], v[28:31]
    v_mfma_f32_16x16x32_bf16 v[16:19], v[80:83], a[96:99], v[16:19]
    ds_read_b128 v[104:107], v12 offset:2048
    v_mfma_f32_16x16x32_bf16 v[20:23], v[80:83], a[100:103], v[20:23]
    v_mfma_f32_16x16x32_bf16 v[24:27], v[84:87], a[96:99], v[24:27]
    s_waitcnt lgkmcnt(3)
    ds_read_b128 v[108:111], v12 offset:2304
    v_mfma_f32_16x16x32_bf16 v[28:31], v[84:87], a[100:103], v[28:31]
    v_mfma_f32_16x16x32_bf16 v[16:19], v[88:91], a[104:107], v[16:19]
    ds_read_b128 v[80:83], v12 offset:4096
    v_mfma_f32_16x16x32_bf16 v[20:23], v[88:91], a[108:111], v[20:23]
    s_waitcnt vmcnt(9)
    s_atomic_add s25, s[26:27], s61 offset:0
    v_mfma_f32_16x16x32_bf16 v[24:27], v[92:95], a[104:107], v[24:27]
    s_waitcnt lgkmcnt(3)
    ds_read_b128 v[84:87], v12 offset:4352
    v_mfma_f32_16x16x32_bf16 v[28:31], v[92:95], a[108:111], v[28:31]
    s_add_u32 s40, s40, 8192
    s_addc_u32 s41, s41, 0
    global_load_dwordx4 v[192:195], v2, s[40:41] offset:-4096 sc1
    v_mfma_f32_16x16x32_bf16 v[32:35], v[96:99], a[0:3], 0
    ds_read_b128 v[88:91], v12 offset:6144
    v_mfma_f32_16x16x32_bf16 v[36:39], v[96:99], a[4:7], 0
    global_load_dwordx4 v[196:199], v3, s[40:41] offset:-4096 sc1
    v_mfma_f32_16x16x32_bf16 v[40:43], v[100:103], a[0:3], 0
    s_waitcnt lgkmcnt(3)
    ds_read_b128 v[92:95], v12 offset:6400
    v_mfma_f32_16x16x32_bf16 v[44:47], v[100:103], a[4:7], 0
    v_mfma_f32_16x16x32_bf16 v[32:35], v[104:107], a[8:11], v[32:35]
    ds_read_b128 v[96:99], v12 offset:8192
    v_mfma_f32_16x16x32_bf16 v[36:39], v[104:107], a[12:15], v[36:39]
    global_load_dwordx4 v[200:203], v7, s[40:41] offset:-4096 sc1
    v_mfma_f32_16x16x32_bf16 v[40:43], v[108:111], a[8:11], v[40:43]
    s_waitcnt lgkmcnt(3)
    ds_read_b128 v[100:103], v12 offset:8448
    v_fma_f32 v112, v16, v16, v9
    v_fma_f32 v113, v17, v17, v9
    v_fma_f32 v114, v18, v18, v9
    v_mfma_f32_16x16x32_bf16 v[44:47], v[108:111], a[12:15], v[44:47]
    v_fma_f32 v115, v19, v19, v9
    v_mul_f32 v112, v16, v112
    v_mfma_f32_16x16x32_bf16 v[32:35], v[80:83], a[16:19], v[32:35]
    ds_read_b128 v[104:107], v12 offset:10240
    v_mul_f32 v113, v17, v113
    v_mul_f32 v114, v18, v114
    v_mfma_f32_16x16x32_bf16 v[36:39], v[80:83], a[20:23], v[36:39]
    global_load_dwordx4 v[204:207], v11, s[40:41] offset:-4096 sc1
    v_mul_f32 v115, v19, v115
    v_exp_f32 v112, v112
    v_mfma_f32_16x16x32_bf16 v[40:43], v[84:87], a[16:19], v[40:43]
    s_waitcnt lgkmcnt(3)
    ds_read_b128 v[108:111], v12 offset:10496
    v_mul_f32 v116, v16, v24
    v_mfma_f32_16x16x32_bf16 v[44:47], v[84:87], a[20:23], v[44:47]
    v_exp_f32 v113, v113
    v_mfma_f32_16x16x32_bf16 v[32:35], v[88:91], a[24:27], v[32:35]
    ds_read_b128 v[80:83], v12 offset:12288
    v_mul_f32 v117, v17, v25
    v_exp_f32 v114, v114
    v_mfma_f32_16x16x32_bf16 v[36:39], v[88:91], a[28:31], v[36:39]
    global_load_dwordx4 v[208:211], v2, s[40:41] offset:0 sc1
    v_mul_f32 v118, v18, v26
    v_mfma_f32_16x16x32_bf16 v[40:43], v[92:95], a[24:27], v[40:43]
    s_waitcnt lgkmcnt(3)
    ds_read_b128 v[84:87], v12 offset:12544
    v_exp_f32 v115, v115
    v_mfma_f32_16x16x32_bf16 v[44:47], v[92:95], a[28:31], v[44:47]
    v_mul_f32 v119, v19, v27
    v_fma_f32 v112, v112, v8, v8
    v_mfma_f32_16x16x32_bf16 v[32:35], v[96:99], a[32:35], v[32:35]
    ds_read_b128 v[88:91], v12 offset:14336
    v_fma_f32 v113, v113, v8, v8
    v_fma_f32 v114, v114, v8, v8
    v_fma_f32 v115, v115, v8, v8
    v_mfma_f32_16x16x32_bf16 v[36:39], v[96:99], a[36:39], v[36:39]
    global_load_dwordx4 v[212:215], v3, s[40:41] offset:0 sc1
    v_rcp_f32 v112, v112
    v_mfma_f32_16x16x32_bf16 v[40:43], v[100:103], a[32:35], v[40:43]
    s_waitcnt lgkmcnt(3)
    ds_read_b128 v[92:95], v12 offset:14592
    v_rcp_f32 v113, v113
    v_mfma_f32_16x16x32_bf16 v[44:47], v[100:103], a[36:39], v[44:47]
    v_rcp_f32 v114, v114
    v_mfma_f32_16x16x32_bf16 v[32:35], v[104:107], a[40:43], v[32:35]
    ds_read_b128 v[96:99], v12 offset:16384
    v_rcp_f32 v115, v115
    v_mfma_f32_16x16x32_bf16 v[36:39], v[104:107], a[44:47], v[36:39]
    global_load_dwordx4 v[216:219], v7, s[40:41] offset:0 sc1
    v_mul_f32 v116, v116, v112
    v_mfma_f32_16x16x32_bf16 v[40:43], v[108:111], a[40:43], v[40:43]
    s_waitcnt lgkmcnt(3)
    ds_read_b128 v[100:103], v12 offset:16640
    v_mul_f32 v117, v117, v113
    v_mul_f32 v118, v118, v114
    v_mfma_f32_16x16x32_bf16 v[44:47], v[108:111], a[44:47], v[44:47]
    v_mul_f32 v119, v119, v115
    v_cvt_pk_bf16_f32 v144, v116, v117
    v_cvt_pk_bf16_f32 v145, v118, v119
    v_mfma_f32_16x16x32_bf16 v[32:35], v[80:83], a[48:51], v[32:35]
    ds_read_b128 v[104:107], v12 offset:18432
    v_fma_f32 v112, v20, v20, v9
    v_fma_f32 v113, v21, v21, v9
    v_mfma_f32_16x16x32_bf16 v[36:39], v[80:83], a[52:55], v[36:39]
    global_load_dwordx4 v[220:223], v11, s[40:41] offset:0 sc1
    v_fma_f32 v114, v22, v22, v9
    v_mfma_f32_16x16x32_bf16 v[40:43], v[84:87], a[48:51], v[40:43]
    s_waitcnt lgkmcnt(3)
    ds_read_b128 v[108:111], v12 offset:18688
    v_fma_f32 v115, v23, v23, v9
    v_mul_f32 v112, v20, v112
    v_mul_f32 v113, v21, v113
    v_mfma_f32_16x16x32_bf16 v[44:47], v[84:87], a[52:55], v[44:47]
    v_mul_f32 v114, v22, v114
    v_mul_f32 v115, v23, v115
    v_mfma_f32_16x16x32_bf16 v[32:35], v[88:91], a[56:59], v[32:35]
    ds_read_b128 v[80:83], v12 offset:20480
    v_exp_f32 v112, v112
    v_mfma_f32_16x16x32_bf16 v[36:39], v[88:91], a[60:63], v[36:39]
    s_add_u32 s40, s40, 8192
    s_addc_u32 s41, s41, 0
    global_load_dwordx4 v[224:227], v2, s[40:41] offset:-4096 sc1
    v_mul_f32 v116, v20, v28
    v_exp_f32 v113, v113
    v_mfma_f32_16x16x32_bf16 v[40:43], v[92:95], a[56:59], v[40:43]
    s_waitcnt lgkmcnt(3)
    ds_read_b128 v[84:87], v12 offset:20736
    v_mul_f32 v117, v21, v29
    v_mfma_f32_16x16x32_bf16 v[44:47], v[92:95], a[60:63], v[44:47]
    v_exp_f32 v114, v114
    v_mfma_f32_16x16x32_bf16 v[32:35], v[96:99], a[64:67], v[32:35]
    ds_read_b128 v[88:91], v12 offset:22528
    v_mul_f32 v118, v22, v30
    v_exp_f32 v115, v115
    v_mfma_f32_16x16x32_bf16 v[36:39], v[96:99], a[68:71], v[36:39]
    global_load_dwordx4 v[228:231], v3, s[40:41] offset:-4096 sc1
    v_mul_f32 v119, v23, v31
    v_mfma_f32_16x16x32_bf16 v[40:43], v[100:103], a[64:67], v[40:43]
    s_waitcnt lgkmcnt(3)
    ds_read_b128 v[92:95], v12 offset:22784
    v_fma_f32 v112, v112, v8, v8
    v_fma_f32 v113, v113, v8, v8
    v_mfma_f32_16x16x32_bf16 v[44:47], v[100:103], a[68:71], v[44:47]
    v_fma_f32 v114, v114, v8, v8
    v_fma_f32 v115, v115, v8, v8
    v_mfma_f32_16x16x32_bf16 v[32:35], v[104:107], a[72:75], v[32:35]
    ds_read_b128 v[96:99], v12 offset:24576
    v_rcp_f32 v112, v112
    v_rcp_f32 v113, v113
    v_mfma_f32_16x16x32_bf16 v[36:39], v[104:107], a[76:79], v[36:39]
    global_load_dwordx4 v[232:235], v7, s[40:41] offset:-4096 sc1
    v_mfma_f32_16x16x32_bf16 v[40:43], v[108:111], a[72:75], v[40:43]
    s_waitcnt lgkmcnt(3)
    ds_read_b128 v[100:103], v12 offset:24832
    v_rcp_f32 v114, v114
    v_mfma_f32_16x16x32_bf16 v[44:47], v[108:111], a[76:79], v[44:47]
    v_rcp_f32 v115, v115
    v_mul_f32 v116, v116, v112
    v_mfma_f32_16x16x32_bf16 v[32:35], v[80:83], a[80:83], v[32:35]
    ds_read_b128 v[104:107], v12 offset:26624
    v_mul_f32 v117, v117, v113
    v_mul_f32 v118, v118, v114
    v_mfma_f32_16x16x32_bf16 v[36:39], v[80:83], a[84:87], v[36:39]
    s_load_dword s4, s[26:27], s57 offset:0 glc
    v_mfma_f32_16x16x32_bf16 v[40:43], v[84:87], a[80:83], v[40:43]
    s_waitcnt lgkmcnt(3)
    ds_read_b128 v[108:111], v12 offset:26880
    v_mul_f32 v119, v119, v115
    v_cvt_pk_bf16_f32 v146, v116, v117
    v_mfma_f32_16x16x32_bf16 v[44:47], v[84:87], a[84:87], v[44:47]
    global_load_dwordx4 v[236:239], v11, s[40:41] offset:-4096 sc1
    v_cvt_pk_bf16_f32 v147, v118, v119
    v_permlane32_swap_b32 v144, v146
    v_mfma_f32_16x16x32_bf16 v[32:35], v[88:91], a[88:91], v[32:35]
    ds_read_b128 v[80:83], v12 offset:28672
    v_permlane32_swap_b32 v145, v147
    s_add_u32 s38, s38, 8192
    s_addc_u32 s39, s39, 0
    global_store_dwordx4 v13, v[144:147], s[38:39] offset:-4096 sc1
    v_mfma_f32_16x16x32_bf16 v[36:39], v[88:91], a[92:95], v[36:39]
    v_mfma_f32_16x16x32_bf16 v[40:43], v[92:95], a[88:91], v[40:43]
    s_waitcnt lgkmcnt(3)
    ds_read_b128 v[84:87], v12 offset:28928
    v_mfma_f32_16x16x32_bf16 v[44:47], v[92:95], a[92:95], v[44:47]
    v_mfma_f32_16x16x32_bf16 v[32:35], v[96:99], a[96:99], v[32:35]
    ds_read_b128 v[88:91], v12 offset:30720
    v_mfma_f32_16x16x32_bf16 v[36:39], v[96:99], a[100:103], v[36:39]
    v_mfma_f32_16x16x32_bf16 v[40:43], v[100:103], a[96:99], v[40:43]
    s_waitcnt lgkmcnt(3)
    ds_read_b128 v[92:95], v12 offset:30976
    v_mfma_f32_16x16x32_bf16 v[44:47], v[100:103], a[100:103], v[44:47]
    global_load_dwordx4 v[240:243], v2, s[40:41] offset:0 sc1
    v_mfma_f32_16x16x32_bf16 v[32:35], v[104:107], a[104:107], v[32:35]
    ds_read_b128 v[96:99], v12 offset:32768
    v_mfma_f32_16x16x32_bf16 v[36:39], v[104:107], a[108:111], v[36:39]
    v_mfma_f32_16x16x32_bf16 v[40:43], v[108:111], a[104:107], v[40:43]
    s_waitcnt lgkmcnt(3)
    ds_read_b128 v[100:103], v12 offset:33024
    v_mfma_f32_16x16x32_bf16 v[44:47], v[108:111], a[108:111], v[44:47]
    global_load_dwordx4 v[244:247], v3, s[40:41] offset:0 sc1
    v_mfma_f32_16x16x32_bf16 v[48:51], v[80:83], a[0:3], 0
    ds_read_b128 v[104:107], v12 offset:34816
    v_mfma_f32_16x16x32_bf16 v[52:55], v[80:83], a[4:7], 0
    v_mfma_f32_16x16x32_bf16 v[56:59], v[84:87], a[0:3], 0
    s_waitcnt lgkmcnt(3)
    ds_read_b128 v[108:111], v12 offset:35072
    v_mfma_f32_16x16x32_bf16 v[60:63], v[84:87], a[4:7], 0
    global_load_dwordx4 v[248:251], v7, s[40:41] offset:0 sc1
    v_mfma_f32_16x16x32_bf16 v[48:51], v[88:91], a[8:11], v[48:51]
    ds_read_b128 v[80:83], v12 offset:36864
    v_mfma_f32_16x16x32_bf16 v[52:55], v[88:91], a[12:15], v[52:55]
    v_mfma_f32_16x16x32_bf16 v[56:59], v[92:95], a[8:11], v[56:59]
    s_waitcnt lgkmcnt(3)
    ds_read_b128 v[84:87], v12 offset:37120
    v_fma_f32 v112, v32, v32, v9
    v_fma_f32 v113, v33, v33, v9
    v_fma_f32 v114, v34, v34, v9
    v_mfma_f32_16x16x32_bf16 v[60:63], v[92:95], a[12:15], v[60:63]
    global_load_dwordx4 v[252:255], v11, s[40:41] offset:0 sc1
    v_fma_f32 v115, v35, v35, v9
    v_mfma_f32_16x16x32_bf16 v[48:51], v[96:99], a[16:19], v[48:51]
    ds_read_b128 v[88:91], v12 offset:38912
    v_mul_f32 v112, v32, v112
    v_mul_f32 v113, v33, v113
    v_mfma_f32_16x16x32_bf16 v[52:55], v[96:99], a[20:23], v[52:55]
    v_mul_f32 v114, v34, v114
    v_mul_f32 v115, v35, v115
    v_exp_f32 v112, v112
    v_mfma_f32_16x16x32_bf16 v[56:59], v[100:103], a[16:19], v[56:59]
    s_waitcnt lgkmcnt(3)
    ds_read_b128 v[92:95], v12 offset:39168
    v_mul_f32 v116, v32, v40
    v_mfma_f32_16x16x32_bf16 v[60:63], v[100:103], a[20:23], v[60:63]
    v_exp_f32 v113, v113
    v_mfma_f32_16x16x32_bf16 v[48:51], v[104:107], a[24:27], v[48:51]
    ds_read_b128 v[96:99], v12 offset:40960
    v_mul_f32 v117, v33, v41
    v_exp_f32 v114, v114
    v_mfma_f32_16x16x32_bf16 v[52:55], v[104:107], a[28:31], v[52:55]
    v_mul_f32 v118, v34, v42
    v_exp_f32 v115, v115
    v_mfma_f32_16x16x32_bf16 v[56:59], v[108:111], a[24:27], v[56:59]
    s_waitcnt lgkmcnt(3)
    ds_read_b128 v[100:103], v12 offset:41216
    v_mul_f32 v119, v35, v43
    v_mfma_f32_16x16x32_bf16 v[60:63], v[108:111], a[28:31], v[60:63]
    s_waitcnt lgkmcnt(0)
    s_cmp_lg_u32 s4, 8
    s_cbranch_scc1 L_e0_spin
L_e0_ok:
    v_mfma_f32_16x16x32_bf16 v[48:51], v[80:83], a[32:35], v[48:51]
    ds_read_b128 v[104:107], v12 offset:43008
    v_fma_f32 v112, v112, v8, v8
    v_fma_f32 v113, v113, v8, v8
    v_fma_f32 v114, v114, v8, v8
    v_mfma_f32_16x16x32_bf16 v[52:55], v[80:83], a[36:39], v[52:55]
    global_load_dwordx4 v[120:123], v6, s[52:53] offset:-4096 sc1
    v_fma_f32 v115, v115, v8, v8
    v_mfma_f32_16x16x32_bf16 v[56:59], v[84:87], a[32:35], v[56:59]
    ds_read_b128 v[108:111], v12 offset:43264
    v_rcp_f32 v112, v112
    v_mfma_f32_16x16x32_bf16 v[60:63], v[84:87], a[36:39], v[60:63]
    global_load_dwordx4 v[124:127], v6, s[52:53] offset:-3840 sc1
    v_rcp_f32 v113, v113
    v_mfma_f32_16x16x32_bf16 v[48:51], v[88:91], a[40:43], v[48:51]
L_pad5:
    s_cbranch_execz L_back1
    ds_read_b128 v[80:83], v12 offset:45056
    v_rcp_f32 v114, v114
    v_mfma_f32_16x16x32_bf16 v[52:55], v[88:91], a[44:47], v[52:55]
    v_rcp_f32 v115, v115
    v_mfma_f32_16x16x32_bf16 v[56:59], v[92:95], a[40:43], v[56:59]
    ds_read_b128 v[84:87], v12 offset:45312
    v_mul_f32 v116, v116, v112
    v_mul_f32 v117, v117, v113
    v_mfma_f32_16x16x32_bf16 v[60:63], v[92:95], a[44:47], v[60:63]
    global_load_dwordx4 v[128:131], v6, s[52:53] offset:-2048 sc1
    v_mul_f32 v118, v118, v114
    v_mul_f32 v119, v119, v115
    v_mfma_f32_16x16x32_bf16 v[48:51], v[96:99], a[48:51], v[48:51]
    ds_read_b128 v[88:91], v12 offset:47104
    v_cvt_pk_bf16_f32 v148, v116, v117
    v_cvt_pk_bf16_f32 v149, v118, v119
    v_mfma_f32_16x16x32_bf16 v[52:55], v[96:99], a[52:55], v[52:55]
    v_fma_f32 v112, v36, v36, v9
    v_fma_f32 v113, v37, v37, v9
    v_mfma_f32_16x16x32_bf16 v[56:59], v[100:103], a[48:51], v[56:59]
    s_waitcnt lgkmcnt(3)
    ds_read_b128 v[92:95], v12 offset:47360
    v_fma_f32 v114, v38, v38, v9
    v_fma_f32 v115, v39, v39, v9
    v_mul_f32 v112, v36, v112
    v_mfma_f32_16x16x32_bf16 v[60:63], v[100:103], a[52:55], v[60:63]
    global_load_dwordx4 v[132:135], v6, s[52:53] offset:-1792 sc1
    v_mul_f32 v113, v37, v113
    v_mfma_f32_16x16x32_bf16 v[48:51], v[104:107], a[56:59], v[48:51]
    ds_read_b128 v[96:99], v12 offset:49152
    v_mul_f32 v114, v38, v114
    v_mul_f32 v115, v39, v115
    v_mfma_f32_16x16x32_bf16 v[52:55], v[104:107], a[60:63], v[52:55]
    v_exp_f32 v112, v112
    v_mul_f32 v116, v36, v44
    v_mfma_f32_16x16x32_bf16 v[56:59], v[108:111], a[56:59], v[56:59]
    s_waitcnt lgkmcnt(3)
    ds_read_b128 v[100:103], v12 offset:49408
    v_exp_f32 v113, v113
    v_mfma_f32_16x16x32_bf16 v[60:63], v[108:111], a[60:63], v[60:63]
    global_load_dwordx4 v[136:139], v6, s[52:53] offset:0 sc1
    v_mul_f32 v117, v37, v45
    v_mfma_f32_16x16x32_bf16 v[48:51], v[80:83], a[64:67], v[48:51]
    ds_read_b128 v[104:107], v12 offset:51200
    v_exp_f32 v114, v114
    v_mfma_f32_16x16x32_bf16 v[52:55], v[80:83], a[68:71], v[52:55]
    s_waitcnt vmcnt(9)
    s_atomic_add s25, s[26:27], s61 offset:4
    v_mul_f32 v118, v38, v46
    v_mfma_f32_16x16x32_bf16 v[56:59], v[84:87], a[64:67], v[56:59]
    s_waitcnt lgkmcnt(3)
    ds_read_b128 v[108:111], v12 offset:51456
    v_exp_f32 v115, v115
    v_mfma_f32_16x16x32_bf16 v[60:63], v[84:87], a[68:71], v[60:63]
    global_load_dwordx4 v[140:143], v6, s[52:53] offset:256 sc1
    v_mul_f32 v119, v39, v47
    v_mfma_f32_16x16x32_bf16 v[48:51], v[88:91], a[72:75], v[48:51]
    ds_read_b128 v[80:83], v12 offset:53248
    v_fma_f32 v112, v112, v8, v8
    v_fma_f32 v113, v113, v8, v8
    v_fma_f32 v114, v114, v8, v8
    v_mfma_f32_16x16x32_bf16 v[52:55], v[88:91], a[76:79], v[52:55]
    v_fma_f32 v115, v115, v8, v8
    v_rcp_f32 v112, v112
    v_mfma_f32_16x16x32_bf16 v[56:59], v[92:95], a[72:75], v[56:59]
    s_waitcnt lgkmcnt(3)
    ds_read_b128 v[84:87], v12 offset:53504
    v_rcp_f32 v113, v113
    v_mfma_f32_16x16x32_bf16 v[60:63], v[92:95], a[76:79], v[60:63]
    global_load_dwordx4 v[160:163], v6, s[52:53] offset:2048 sc1
    v_rcp_f32 v114, v114
    v_mfma_f32_16x16x32_bf16 v[48:51], v[96:99], a[80:83], v[48:51]
    ds_read_b128 v[88:91], v12 offset:55296
    v_rcp_f32 v115, v115
    v_mfma_f32_16x16x32_bf16 v[52:55], v[96:99], a[84:87], v[52:55]
    v_mul_f32 v116, v116, v112
    v_mfma_f32_16x16x32_bf16 v[56:59], v[100:103], a[80:83], v[56:59]
    s_waitcnt lgkmcnt(3)
    ds_read_b128 v[92:95], v12 offset:55552
    v_mul_f32 v117, v117, v113
    v_mul_f32 v118, v118, v114
    v_mfma_f32_16x16x32_bf16 v[60:63], v[100:103], a[84:87], v[60:63]
    global_load_dwordx4 v[164:167], v6, s[52:53] offset:2304 sc1
    v_mul_f32 v119, v119, v115
    v_cvt_pk_bf16_f32 v150, v116, v117
    v_mfma_f32_16x16x32_bf16 v[48:51], v[104:107], a[88:91], v[48:51]
    v_cvt_pk_bf16_f32 v151, v118, v119
    v_permlane32_swap_b32 v148, v150
    v_mfma_f32_16x16x32_bf16 v[52:55], v[104:107], a[92:95], v[52:55]
    v_permlane32_swap_b32 v149, v151
    global_store_dwordx4 v13, v[148:151], s[38:39] offset:0 sc1
    v_mfma_f32_16x16x32_bf16 v[56:59], v[108:111], a[88:91], v[56:59]
    s_waitcnt lgkmcnt(2)
    v_mfma_f32_16x16x32_bf16 v[60:63], v[108:111], a[92:95], v[60:63]
    v_mfma_f32_16x16x32_bf16 v[48:51], v[80:83], a[96:99], v[48:51]
    v_mfma_f32_16x16x32_bf16 v[52:55], v[80:83], a[100:103], v[52:55]
    v_mfma_f32_16x16x32_bf16 v[56:59], v[84:87], a[96:99], v[56:59]
    s_waitcnt lgkmcnt(0)
    v_mfma_f32_16x16x32_bf16 v[60:63], v[84:87], a[100:103], v[60:63]
    v_mfma_f32_16x16x32_bf16 v[48:51], v[88:91], a[104:107], v[48:51]
    v_mfma_f32_16x16x32_bf16 v[52:55], v[88:91], a[108:111], v[52:55]
    s_add_u32 s52, s52, 8192
    s_addc_u32 s53, s53, 0
    global_load_dwordx4 v[168:171], v6, s[52:53] offset:-4096 sc1
    v_mfma_f32_16x16x32_bf16 v[56:59], v[92:95], a[104:107], v[56:59]
    v_mfma_f32_16x16x32_bf16 v[60:63], v[92:95], a[108:111], v[60:63]
    global_load_dwordx4 v[172:175], v6, s[52:53] offset:-3840 sc1
    s_nop 0
    v_pk_fma_f32 v[112:113], v[48:49], v[48:49], v[8:9] op_sel:[0,0,1] op_sel_hi:[1,1,1]
    v_pk_fma_f32 v[114:115], v[50:51], v[50:51], v[8:9] op_sel:[0,0,1] op_sel_hi:[1,1,1]
    v_pk_fma_f32 v[116:117], v[52:53], v[52:53], v[8:9] op_sel:[0,0,1] op_sel_hi:[1,1,1]
    v_pk_fma_f32 v[118:119], v[54:55], v[54:55], v[8:9] op_sel:[0,0,1] op_sel_hi:[1,1,1]
    v_pk_mul_f32 v[112:113], v[48:49], v[112:113]
    v_pk_mul_f32 v[114:115], v[50:51], v[114:115]
    v_pk_mul_f32 v[116:117], v[52:53], v[116:117]
    global_load_dwordx4 a[0:3], v6, s[52:53] offset:-2048 sc1
    v_pk_mul_f32 v[118:119], v[54:55], v[118:119]
    v_exp_f32 v112, v112
    v_exp_f32 v113, v113
    v_exp_f32 v114, v114
    v_exp_f32 v115, v115
    v_exp_f32 v116, v116
    v_exp_f32 v117, v117
    v_exp_f32 v118, v118
    v_exp_f32 v119, v119
    v_pk_mul_f32 v[48:49], v[48:49], v[56:57]
    v_pk_mul_f32 v[50:51], v[50:51], v[58:59]
    v_pk_mul_f32 v[52:53], v[52:53], v[60:61]
    global_load_dwordx4 a[4:7], v6, s[52:53] offset:-1792 sc1
    v_pk_mul_f32 v[54:55], v[54:55], v[62:63]
    v_pk_fma_f32 v[112:113], v[112:113], v[8:9], v[8:9] op_sel_hi:[1,0,0]
    v_pk_fma_f32 v[114:115], v[114:115], v[8:9], v[8:9] op_sel_hi:[1,0,0]
    v_pk_fma_f32 v[116:117], v[116:117], v[8:9], v[8:9] op_sel_hi:[1,0,0]
    global_load_dwordx4 a[8:11], v6, s[54:55] offset:-4096 sc1
    v_pk_fma_f32 v[118:119], v[118:119], v[8:9], v[8:9] op_sel_hi:[1,0,0]
    v_rcp_f32 v112, v112
    v_rcp_f32 v113, v113
    v_rcp_f32 v114, v114
    v_rcp_f32 v115, v115
    v_rcp_f32 v116, v116
    v_rcp_f32 v117, v117
    v_rcp_f32 v118, v118
    v_rcp_f32 v119, v119
    v_pk_mul_f32 v[48:49], v[48:49], v[112:113]
    v_pk_mul_f32 v[50:51], v[50:51], v[114:115]
    v_pk_mul_f32 v[52:53], v[52:53], v[116:117]
    global_load_dwordx4 a[12:15], v6, s[54:55] offset:-3840 sc1
    v_pk_mul_f32 v[54:55], v[54:55], v[118:119]
    v_cvt_pk_bf16_f32 v152, v48, v49
    v_cvt_pk_bf16_f32 v153, v50, v51
    v_cvt_pk_bf16_f32 v154, v52, v53
    v_cvt_pk_bf16_f32 v155, v54, v55
    s_nop 0
    v_permlane32_swap_b32 v152, v154
    v_permlane32_swap_b32 v153, v155
    s_add_u32 s38, s38, 8192
    s_addc_u32 s39, s39, 0
    global_store_dwordx4 v13, v[152:155], s[38:39] offset:-4096 sc1
    s_cmp_eq_u32 s32, 7
    s_cbranch_scc1 L_noe
    s_waitcnt vmcnt(15)
    v_mfma_f32_16x16x32_bf16 v[16:19], a[112:115], v[120:123], 0
    s_waitcnt vmcnt(14)
    v_mfma_f32_16x16x32_bf16 v[20:23], a[112:115], v[124:127], 0
    s_mul_i32 s6, s31, 56
    s_lshl2_add_u32 s63, s32, s28
    s_add_u32 s6, s6, s63
    v_mfma_f32_16x16x32_bf16 v[24:27], a[116:119], v[120:123], 0
    v_mfma_f32_16x16x32_bf16 v[28:31], a[116:119], v[124:127], 0
    s_load_dword s4, s[26:27], s57 offset:4 glc
    s_lshl_b32 s6, s6, 10
    s_add_u32 s6, s6, 9502720
    v_and_b32 v4, 0x2f0, v6
    v_lshrrev_b32 v5, 5, v0
    v_mfma_f32_16x16x32_bf16 v[32:35], a[120:123], v[120:123], 0
    v_mfma_f32_16x16x32_bf16 v[36:39], a[120:123], v[124:127], 0
    v_lshl_or_b32 v4, v5, 8, v4
    v_add_u32 v4, s6, v4
    v_add_u32 v5, 28672, v4
    v_mfma_f32_16x16x32_bf16 v[40:43], a[124:127], v[120:123], 0
    v_mfma_f32_16x16x32_bf16 v[44:47], a[124:127], v[124:127], 0
    global_load_dwordx4 a[16:19], v6, s[54:55] offset:-2048 sc1
    s_xor_b32 s3, s28, 1
    s_mul_i32 s3, s3, 6144
    s_add_u32 s3, s3, 57344
    v_add_u32 v72, s3, v1
    s_waitcnt vmcnt(14)
    v_mfma_f32_16x16x32_bf16 v[16:19], a[128:131], v[128:131], v[16:19]
    s_waitcnt vmcnt(13)
    v_mfma_f32_16x16x32_bf16 v[20:23], a[128:131], v[132:135], v[20:23]
    s_xor_b32 s3, s28, 2
    s_mul_i32 s3, s3, 6144
    s_add_u32 s3, s3, 59392
    v_add_u32 v73, s3, v1
    v_mfma_f32_16x16x32_bf16 v[24:27], a[132:135], v[128:131], v[24:27]
    v_mfma_f32_16x16x32_bf16 v[28:31], a[132:135], v[132:135], v[28:31]
    global_load_dwordx4 a[20:23], v6, s[54:55] offset:-1792 sc1
    s_xor_b32 s3, s28, 3
    s_mul_i32 s3, s3, 6144
    s_add_u32 s3, s3, 61440
    v_add_u32 v74, s3, v1
    v_mfma_f32_16x16x32_bf16 v[32:35], a[136:139], v[128:131], v[32:35]
    v_mfma_f32_16x16x32_bf16 v[36:39], a[136:139], v[132:135], v[36:39]
    s_mul_i32 s3, s28, 6144
    s_add_u32 s3, s3, 57344
    v_add_u32 v75, s3, v1
    v_mfma_f32_16x16x32_bf16 v[40:43], a[140:143], v[128:131], v[40:43]
    v_mfma_f32_16x16x32_bf16 v[44:47], a[140:143], v[132:135], v[44:47]
    global_load_dwordx4 a[24:27], v6, s[54:55] offset:0 sc1
    v_and_b32 v76, 15, v0
    v_lshrrev_b32 v77, 5, v0
    v_lshl_or_b32 v76, v77, 4, v76
    s_waitcnt vmcnt(14)
    v_mfma_f32_16x16x32_bf16 v[16:19], a[144:147], v[136:139], v[16:19]
    s_waitcnt vmcnt(13)
    v_mfma_f32_16x16x32_bf16 v[20:23], a[144:147], v[140:143], v[20:23]
    v_mul_u32_u24 v76, 896, v76
    v_and_b32 v77, 16, v0
    v_add_u32 v76, v76, v77
    v_mfma_f32_16x16x32_bf16 v[24:27], a[148:151], v[136:139], v[24:27]
    v_mfma_f32_16x16x32_bf16 v[28:31], a[148:151], v[140:143], v[28:31]
    global_load_dwordx4 a[28:31], v6, s[54:55] offset:256 sc1
    s_mul_i32 s3, s31, 64*896
    s_lshl_b32 s63, s63, 5
    s_add_u32 s3, s3, s63
    v_add_u32 v76, s3, v76
    v_mfma_f32_16x16x32_bf16 v[32:35], a[152:155], v[136:139], v[32:35]
    v_mfma_f32_16x16x32_bf16 v[36:39], a[152:155], v[140:143], v[36:39]
    v_add_u32 v77, 32*896, v76
    v_mfma_f32_16x16x32_bf16 v[40:43], a[156:159], v[136:139], v[40:43]
    v_mfma_f32_16x16x32_bf16 v[44:47], a[156:159], v[140:143], v[44:47]
    global_load_dwordx4 a[32:35], v6, s[54:55] offset:2048 sc1
    s_waitcnt vmcnt(14)
    v_mfma_f32_16x16x32_bf16 v[16:19], a[160:163], v[160:163], v[16:19]
    s_waitcnt vmcnt(13)
    v_mfma_f32_16x16x32_bf16 v[20:23], a[160:163], v[164:167], v[20:23]
    v_mfma_f32_16x16x32_bf16 v[24:27], a[164:167], v[160:163], v[24:27]
    v_mfma_f32_16x16x32_bf16 v[28:31], a[164:167], v[164:167], v[28:31]
    global_load_dwordx4 a[36:39], v6, s[54:55] offset:2304 sc1
    v_mfma_f32_16x16x32_bf16 v[32:35], a[168:171], v[160:163], v[32:35]
    v_mfma_f32_16x16x32_bf16 v[36:39], a[168:171], v[164:167], v[36:39]
    v_mfma_f32_16x16x32_bf16 v[40:43], a[172:175], v[160:163], v[40:43]
    v_mfma_f32_16x16x32_bf16 v[44:47], a[172:175], v[164:167], v[44:47]
    s_add_u32 s54, s54, 8192
    s_addc_u32 s55, s55, 0
    global_load_dwordx4 a[40:43], v6, s[54:55] offset:-4096 sc1
    s_waitcnt vmcnt(13)
    v_mfma_f32_16x16x32_bf16 v[16:19], a[176:179], v[168:171], v[16:19]
    s_waitcnt vmcnt(12)
    v_mfma_f32_16x16x32_bf16 v[20:23], a[176:179], v[172:175], v[20:23]
    s_waitcnt lgkmcnt(0)
    s_cmp_lg_u32 s4, 8
    s_cbranch_scc1 L_e1_spin
L_e1_ok:
    v_mfma_f32_16x16x32_bf16 v[24:27], a[180:183], v[168:171], v[24:27]
    v_mfma_f32_16x16x32_bf16 v[28:31], a[180:183], v[172:175], v[28:31]
    global_load_dwordx4 a[44:47], v6, s[54:55] offset:-3840 sc1
    v_mfma_f32_16x16x32_bf16 v[32:35], a[184:187], v[168:171], v[32:35]
    v_mfma_f32_16x16x32_bf16 v[36:39], a[184:187], v[172:175], v[36:39]
    v_mfma_f32_16x16x32_bf16 v[40:43], a[188:191], v[168:171], v[40:43]
    v_mfma_f32_16x16x32_bf16 v[44:47], a[188:191], v[172:175], v[44:47]
    global_load_dwordx4 a[48:51], v6, s[54:55] offset:-2048 sc1
    s_waitcnt vmcnt(13)
    v_mfma_f32_16x16x32_bf16 v[16:19], a[192:195], a[0:3], v[16:19]
    s_waitcnt vmcnt(12)
    v_mfma_f32_16x16x32_bf16 v[20:23], a[192:195], a[4:7], v[20:23]
    v_mfma_f32_16x16x32_bf16 v[24:27], a[196:199], a[0:3], v[24:27]
    v_mfma_f32_16x16x32_bf16 v[28:31], a[196:199], a[4:7], v[28:31]
    global_load_dwordx4 a[52:55], v6, s[54:55] offset:-1792 sc1
    v_mfma_f32_16x16x32_bf16 v[32:35], a[200:203], a[0:3], v[32:35]
    v_mfma_f32_16x16x32_bf16 v[36:39], a[200:203], a[4:7], v[36:39]
    s_waitcnt vmcnt(10)
    s_atomic_add s25, s[26:27], s61 offset:8
    v_mfma_f32_16x16x32_bf16 v[40:43], a[204:207], a[0:3], v[40:43]
    v_mfma_f32_16x16x32_bf16 v[44:47], a[204:207], a[4:7], v[44:47]
    global_load_dwordx4 a[56:59], v6, s[52:53] offset:0 sc1
    v_mfma_f32_16x16x32_bf16 v[80:83], a[112:115], a[8:11], 0
    v_mfma_f32_16x16x32_bf16 v[84:87], a[112:115], a[12:15], 0
    v_mfma_f32_16x16x32_bf16 v[88:91], a[116:119], a[8:11], 0
    v_mfma_f32_16x16x32_bf16 v[92:95], a[116:119], a[12:15], 0
    global_load_dwordx4 a[60:63], v6, s[52:53] offset:256 sc1
    v_mfma_f32_16x16x32_bf16 v[96:99], a[120:123], a[8:11], 0
    v_mfma_f32_16x16x32_bf16 v[100:103], a[120:123], a[12:15], 0
    v_mfma_f32_16x16x32_bf16 v[104:107], a[124:127], a[8:11], 0
    v_mfma_f32_16x16x32_bf16 v[108:111], a[124:127], a[12:15], 0
    global_load_dwordx4 a[64:67], v6, s[52:53] offset:2048 sc1
    s_waitcnt vmcnt(12)
    v_mfma_f32_16x16x32_bf16 v[80:83], a[128:131], a[16:19], v[80:83]
    s_waitcnt vmcnt(11)
    v_mfma_f32_16x16x32_bf16 v[84:87], a[128:131], a[20:23], v[84:87]
    v_mfma_f32_16x16x32_bf16 v[88:91], a[132:135], a[16:19], v[88:91]
    v_mfma_f32_16x16x32_bf16 v[92:95], a[132:135], a[20:23], v[92:95]
    global_load_dwordx4 a[68:71], v6, s[52:53] offset:2304 sc1
    v_mfma_f32_16x16x32_bf16 v[96:99], a[136:139], a[16:19], v[96:99]
    v_mfma_f32_16x16x32_bf16 v[100:103], a[136:139], a[20:23], v[100:103]
    v_mfma_f32_16x16x32_bf16 v[104:107], a[140:143], a[16:19], v[104:107]
    v_mfma_f32_16x16x32_bf16 v[108:111], a[140:143], a[20:23], v[108:111]
    s_add_u32 s52, s52, 8192
    s_addc_u32 s53, s53, 0
    global_load_dwordx4 a[72:75], v6, s[52:53] offset:-4096 sc1
    s_waitcnt vmcnt(12)
    v_mfma_f32_16x16x32_bf16 v[80:83], a[144:147], a[24:27], v[80:83]
    s_waitcnt vmcnt(11)
    v_mfma_f32_16x16x32_bf16 v[84:87], a[144:147], a[28:31], v[84:87]
    v_mfma_f32_16x16x32_bf16 v[88:91], a[148:151], a[24:27], v[88:91]
    v_mfma_f32_16x16x32_bf16 v[92:95], a[148:151], a[28:31], v[92:95]
    global_load_dwordx4 a[76:79], v6, s[52:53] offset:-3840 sc1
    v_mfma_f32_16x16x32_bf16 v[96:99], a[152:155], a[24:27], v[96:99]
    v_mfma_f32_16x16x32_bf16 v[100:103], a[152:155], a[28:31], v[100:103]
    v_mfma_f32_16x16x32_bf16 v[104:107], a[156:159], a[24:27], v[104:107]
    v_mfma_f32_16x16x32_bf16 v[108:111], a[156:159], a[28:31], v[108:111]
    global_load_dwordx4 a[80:83], v6, s[52:53] offset:-2048 sc1
    s_waitcnt vmcnt(12)
    v_mfma_f32_16x16x32_bf16 v[80:83], a[160:163], a[32:35], v[80:83]
    s_waitcnt vmcnt(11)
    v_mfma_f32_16x16x32_bf16 v[84:87], a[160:163], a[36:39], v[84:87]
    v_mfma_f32_16x16x32_bf16 v[88:91], a[164:167], a[32:35], v[88:91]
    v_mfma_f32_16x16x32_bf16 v[92:95], a[164:167], a[36:39], v[92:95]
    global_load_dwordx4 a[84:87], v6, s[52:53] offset:-1792 sc1
    v_mfma_f32_16x16x32_bf16 v[96:99], a[168:171], a[32:35], v[96:99]
    v_mfma_f32_16x16x32_bf16 v[100:103], a[168:171], a[36:39], v[100:103]
    v_mfma_f32_16x16x32_bf16 v[104:107], a[172:175], a[32:35], v[104:107]
    v_mfma_f32_16x16x32_bf16 v[108:111], a[172:175], a[36:39], v[108:111]
    global_load_dwordx4 a[88:91], v6, s[54:55] offset:0 sc1
    s_waitcnt vmcnt(12)
    v_mfma_f32_16x16x32_bf16 v[80:83], a[176:179], a[40:43], v[80:83]
    s_waitcnt vmcnt(11)
    v_mfma_f32_16x16x32_bf16 v[84:87], a[176:179], a[44:47], v[84:87]
    v_mfma_f32_16x16x32_bf16 v[88:91], a[180:183], a[40:43], v[88:91]
    v_mfma_f32_16x16x32_bf16 v[92:95], a[180:183], a[44:47], v[92:95]
    global_load_dwordx4 a[92:95], v6, s[54:55] offset:256 sc1
    v_mfma_f32_16x16x32_bf16 v[96:99], a[184:187], a[40:43], v[96:99]
    v_mfma_f32_16x16x32_bf16 v[100:103], a[184:187], a[44:47], v[100:103]
    s_load_dword s4, s[26:27], s57 offset:8 glc
    v_mfma_f32_16x16x32_bf16 v[104:107], a[188:191], a[40:43], v[104:107]
    v_mfma_f32_16x16x32_bf16 v[108:111], a[188:191], a[44:47], v[108:111]
    global_load_dwordx4 a[96:99], v6, s[54:55] offset:2048 sc1
    s_waitcnt vmcnt(12)
    v_mfma_f32_16x16x32_bf16 v[80:83], a[192:195], a[48:51], v[80:83]
    s_waitcnt vmcnt(11)
    v_mfma_f32_16x16x32_bf16 v[84:87], a[192:195], a[52:55], v[84:87]
    v_mfma_f32_16x16x32_bf16 v[88:91], a[196:199], a[48:51], v[88:91]
    v_mfma_f32_16x16x32_bf16 v[92:95], a[196:199], a[52:55], v[92:95]
    global_load_dwordx4 a[100:103], v6, s[54:55] offset:2304 sc1
    v_mfma_f32_16x16x32_bf16 v[96:99], a[200:203], a[48:51], v[96:99]
    v_mfma_f32_16x16x32_bf16 v[100:103], a[200:203], a[52:55], v[100:103]
    v_mfma_f32_16x16x32_bf16 v[104:107], a[204:207], a[48:51], v[104:107]
    v_mfma_f32_16x16x32_bf16 v[108:111], a[204:207], a[52:55], v[108:111]
    s_add_u32 s54, s54, 8192
    s_addc_u32 s55, s55, 0
    global_load_dwordx4 a[104:107], v6, s[54:55] offset:-4096 sc1
    s_waitcnt vmcnt(12)
    v_mfma_f32_16x16x32_bf16 v[16:19], a[208:211], a[56:59], v[16:19]
    s_waitcnt vmcnt(11)
    v_mfma_f32_16x16x32_bf16 v[20:23], a[208:211], a[60:63], v[20:23]
    v_mfma_f32_16x16x32_bf16 v[24:27], a[212:215], a[56:59], v[24:27]
    v_mfma_f32_16x16x32_bf16 v[28:31], a[212:215], a[60:63], v[28:31]
    global_load_dwordx4 a[108:111], v6, s[54:55] offset:-3840 sc1
    v_mfma_f32_16x16x32_bf16 v[32:35], a[216:219], a[56:59], v[32:35]
    v_mfma_f32_16x16x32_bf16 v[36:39], a[216:219], a[60:63], v[36:39]
    v_mfma_f32_16x16x32_bf16 v[40:43], a[220:223], a[56:59], v[40:43]
    v_mfma_f32_16x16x32_bf16 v[44:47], a[220:223], a[60:63], v[44:47]
    global_load_dwordx4 a[0:3], v6, s[54:55] offset:-2048 sc1
    s_waitcnt vmcnt(12)
    v_mfma_f32_16x16x32_bf16 v[16:19], a[224:227], a[64:67], v[16:19]
    s_waitcnt vmcnt(11)
    v_mfma_f32_16x16x32_bf16 v[20:23], a[224:227], a[68:71], v[20:23]
    v_mfma_f32_16x16x32_bf16 v[24:27], a[228:231], a[64:67], v[24:27]
    v_mfma_f32_16x16x32_bf16 v[28:31], a[228:231], a[68:71], v[28:31]
    global_load_dwordx4 a[4:7], v6, s[54:55] offset:-1792 sc1
    v_mfma_f32_16x16x32_bf16 v[32:35], a[232:235], a[64:67], v[32:35]
    v_mfma_f32_16x16x32_bf16 v[36:39], a[232:235], a[68:71], v[36:39]
    v_mfma_f32_16x16x32_bf16 v[40:43], a[236:239], a[64:67], v[40:43]
    v_mfma_f32_16x16x32_bf16 v[44:47], a[236:239], a[68:71], v[44:47]
    global_load_dwordx4 v[64:67], v4, s[26:27] sc1
    s_waitcnt vmcnt(12)
    v_mfma_f32_16x16x32_bf16 v[16:19], a[240:243], a[72:75], v[16:19]
    s_waitcnt vmcnt(11)
    v_mfma_f32_16x16x32_bf16 v[20:23], a[240:243], a[76:79], v[20:23]
    v_mfma_f32_16x16x32_bf16 v[24:27], a[244:247], a[72:75], v[24:27]
    v_mfma_f32_16x16x32_bf16 v[28:31], a[244:247], a[76:79], v[28:31]
    s_waitcnt lgkmcnt(0)
    s_cmp_lg_u32 s4, 8
    s_cbranch_scc1 L_e2_spin
L_e2_ok:
    v_mfma_f32_16x16x32_bf16 v[32:35], a[248:251], a[72:75], v[32:35]
    v_mfma_f32_16x16x32_bf16 v[36:39], a[248:251], a[76:79], v[36:39]
    global_load_dwordx4 a[8:11], v6, s[52:53] offset:0 sc1
    v_mfma_f32_16x16x32_bf16 v[40:43], a[252:255], a[72:75], v[40:43]
    v_mfma_f32_16x16x32_bf16 v[44:47], a[252:255], a[76:79], v[44:47]
    global_load_dwordx4 v[68:71], v5, s[26:27] sc1
    s_waitcnt vmcnt(12)
    v_mfma_f32_16x16x32_bf16 v[16:19], v[176:179], a[80:83], v[16:19]
    s_waitcnt vmcnt(11)
    v_mfma_f32_16x16x32_bf16 v[20:23], v[176:179], a[84:87], v[20:23]
    v_mfma_f32_16x16x32_bf16 v[24:27], v[180:183], a[80:83], v[24:27]
    v_mfma_f32_16x16x32_bf16 v[28:31], v[180:183], a[84:87], v[28:31]
    global_load_dwordx4 a[12:15], v6, s[52:53] offset:256 sc1
    v_mfma_f32_16x16x32_bf16 v[32:35], v[184:187], a[80:83], v[32:35]
    v_mfma_f32_16x16x32_bf16 v[36:39], v[184:187], a[84:87], v[36:39]
    v_mfma_f32_16x16x32_bf16 v[40:43], v[188:191], a[80:83], v[40:43]
    v_mfma_f32_16x16x32_bf16 v[44:47], v[188:191], a[84:87], v[44:47]
    global_load_dwordx4 a[16:19], v6, s[52:53] offset:2048 sc1
    s_waitcnt vmcnt(12)
    v_mfma_f32_16x16x32_bf16 v[80:83], a[208:211], a[88:91], v[80:83]
    s_waitcnt vmcnt(11)
    v_mfma_f32_16x16x32_bf16 v[84:87], a[208:211], a[92:95], v[84:87]
    v_mfma_f32_16x16x32_bf16 v[88:91], a[212:215], a[88:91], v[88:91]
    v_mfma_f32_16x16x32_bf16 v[92:95], a[212:215], a[92:95], v[92:95]
    global_load_dwordx4 a[20:23], v6, s[52:53] offset:2304 sc1
    v_mfma_f32_16x16x32_bf16 v[96:99], a[216:219], a[88:91], v[96:99]
    v_mfma_f32_16x16x32_bf16 v[100:103], a[216:219], a[92:95], v[100:103]
    v_mfma_f32_16x16x32_bf16 v[104:107], a[220:223], a[88:91], v[104:107]
    v_mfma_f32_16x16x32_bf16 v[108:111], a[220:223], a[92:95], v[108:111]
    global_load_dwordx4 a[24:27], v6, s[54:55] offset:0 sc1
    s_waitcnt vmcnt(12)
    v_mfma_f32_16x16x32_bf16 v[80:83], a[224:227], a[96:99], v[80:83]
    s_waitcnt vmcnt(11)
    v_mfma_f32_16x16x32_bf16 v[84:87], a[224:227], a[100:103], v[84:87]
    v_mfma_f32_16x16x32_bf16 v[88:91], a[228:231], a[96:99], v[88:91]
    v_mfma_f32_16x16x32_bf16 v[92:95], a[228:231], a[100:103], v[92:95]
    global_load_dwordx4 a[28:31], v6, s[54:55] offset:256 sc1
    v_mfma_f32_16x16x32_bf16 v[96:99], a[232:235], a[96:99], v[96:99]
    v_mfma_f32_16x16x32_bf16 v[100:103], a[232:235], a[100:103], v[100:103]
    v_mfma_f32_16x16x32_bf16 v[104:107], a[236:239], a[96:99], v[104:107]
    v_mfma_f32_16x16x32_bf16 v[108:111], a[236:239], a[100:103], v[108:111]
    global_load_dwordx4 a[32:35], v6, s[54:55] offset:2048 sc1
    s_waitcnt vmcnt(12)
    v_mfma_f32_16x16x32_bf16 v[80:83], a[240:243], a[104:107], v[80:83]
    s_waitcnt vmcnt(11)
    v_mfma_f32_16x16x32_bf16 v[84:87], a[240:243], a[108:111], v[84:87]
    v_mfma_f32_16x16x32_bf16 v[88:91], a[244:247], a[104:107], v[88:91]
    v_mfma_f32_16x16x32_bf16 v[92:95], a[244:247], a[108:111], v[92:95]
    global_load_dwordx4 a[36:39], v6, s[54:55] offset:2304 sc1
    v_mfma_f32_16x16x32_bf16 v[96:99], a[248:251], a[104:107], v[96:99]
    v_mfma_f32_16x16x32_bf16 v[100:103], a[248:251], a[108:111], v[100:103]
    v_mfma_f32_16x16x32_bf16 v[104:107], a[252:255], a[104:107], v[104:107]
    v_mfma_f32_16x16x32_bf16 v[108:111], a[252:255], a[108:111], v[108:111]
    s_add_u32 s52, s52, 8192
    s_addc_u32 s53, s53, 0
    global_load_dwordx4 a[40:43], v6, s[52:53] offset:-4096 sc1
    s_waitcnt vmcnt(12)
    v_mfma_f32_16x16x32_bf16 v[80:83], v[176:179], a[0:3], v[80:83]
    s_waitcnt vmcnt(11)
    v_mfma_f32_16x16x32_bf16 v[84:87], v[176:179], a[4:7], v[84:87]
    s_waitcnt vmcnt(10)
    v_lshlrev_b32 v48, 16, v64
    v_and_b32 v49, 0xffff0000, v64
    v_mfma_f32_16x16x32_bf16 v[88:91], v[180:183], a[0:3], v[88:91]
    v_mfma_f32_16x16x32_bf16 v[92:95], v[180:183], a[4:7], v[92:95]
    global_load_dwordx4 a[44:47], v6, s[52:53] offset:-3840 sc1
    v_lshlrev_b32 v50, 16, v65
    v_and_b32 v51, 0xffff0000, v65
    v_mfma_f32_16x16x32_bf16 v[96:99], v[184:187], a[0:3], v[96:99]
    v_mfma_f32_16x16x32_bf16 v[100:103], v[184:187], a[4:7], v[100:103]
    v_lshlrev_b32 v52, 16, v66
    v_and_b32 v53, 0xffff0000, v66
    v_mfma_f32_16x16x32_bf16 v[104:107], v[188:191], a[0:3], v[104:107]
    v_mfma_f32_16x16x32_bf16 v[108:111], v[188:191], a[4:7], v[108:111]
    global_load_dwordx4 a[48:51], v6, s[52:53] offset:-2048 sc1
    v_lshlrev_b32 v54, 16, v67
    v_and_b32 v55, 0xffff0000, v67
    s_waitcnt vmcnt(11)
    v_mfma_f32_16x16x32_bf16 v[16:19], v[192:195], a[8:11], v[16:19]
    s_waitcnt vmcnt(9)
    v_mfma_f32_16x16x32_bf16 v[20:23], v[192:195], a[12:15], v[20:23]
    v_lshlrev_b32 v56, 16, v68
    v_and_b32 v57, 0xffff0000, v68
    v_mfma_f32_16x16x32_bf16 v[24:27], v[196:199], a[8:11], v[24:27]
    v_mfma_f32_16x16x32_bf16 v[28:31], v[196:199], a[12:15], v[28:31]
    global_load_dwordx4 a[52:55], v6, s[52:53] offset:-1792 sc1
    v_lshlrev_b32 v58, 16, v69
    v_and_b32 v59, 0xffff0000, v69
    v_mfma_f32_16x16x32_bf16 v[32:35], v[200:203], a[8:11], v[32:35]
    v_mfma_f32_16x16x32_bf16 v[36:39], v[200:203], a[12:15], v[36:39]
    v_lshlrev_b32 v60, 16, v70
    v_and_b32 v61, 0xffff0000, v70
    v_mfma_f32_16x16x32_bf16 v[40:43], v[204:207], a[8:11], v[40:43]
    v_mfma_f32_16x16x32_bf16 v[44:47], v[204:207], a[12:15], v[44:47]
    s_add_u32 s54, s54, 8192
    s_addc_u32 s55, s55, 0
    global_load_dwordx4 a[56:59], v6, s[54:55] offset:-4096 sc1
    v_lshlrev_b32 v62, 16, v71
    v_and_b32 v63, 0xffff0000, v71
    s_waitcnt vmcnt(10)
    v_mfma_f32_16x16x32_bf16 v[16:19], v[208:211], a[16:19], v[16:19]
    s_waitcnt vmcnt(9)
    v_mfma_f32_16x16x32_bf16 v[20:23], v[208:211], a[20:23], v[20:23]
    v_permlane32_swap_b32 v48, v52
    v_permlane32_swap_b32 v49, v53
    v_mfma_f32_16x16x32_bf16 v[24:27], v[212:215], a[16:19], v[24:27]
    v_mfma_f32_16x16x32_bf16 v[28:31], v[212:215], a[20:23], v[28:31]
    global_load_dwordx4 a[60:63], v6, s[54:55] offset:-3840 sc1
    v_permlane32_swap_b32 v50, v54
    v_permlane32_swap_b32 v51, v55
    v_mfma_f32_16x16x32_bf16 v[32:35], v[216:219], a[16:19], v[32:35]
    v_mfma_f32_16x16x32_bf16 v[36:39], v[216:219], a[20:23], v[36:39]
    v_permlane32_swap_b32 v56, v60
    v_permlane32_swap_b32 v57, v61
    v_mfma_f32_16x16x32_bf16 v[40:43], v[220:223], a[16:19], v[40:43]
    v_mfma_f32_16x16x32_bf16 v[44:47], v[220:223], a[20:23], v[44:47]
    global_load_dwordx4 a[64:67], v6, s[54:55] offset:-2048 sc1
    v_permlane32_swap_b32 v58, v62
    v_permlane32_swap_b32 v59, v63
    s_waitcnt vmcnt(10)
    v_mfma_f32_16x16x32_bf16 v[80:83], v[192:195], a[24:27], v[80:83]
    s_waitcnt vmcnt(9)
    v_mfma_f32_16x16x32_bf16 v[84:87], v[192:195], a[28:31], v[84:87]
    v_mfma_f32_16x16x32_bf16 v[88:91], v[196:199], a[24:27], v[88:91]
    v_mfma_f32_16x16x32_bf16 v[92:95], v[196:199], a[28:31], v[92:95]
    global_load_dwordx4 a[68:71], v6, s[54:55] offset:-1792 sc1
    v_mfma_f32_16x16x32_bf16 v[96:99], v[200:203], a[24:27], v[96:99]
    v_mfma_f32_16x16x32_bf16 v[100:103], v[200:203], a[28:31], v[100:103]
    v_mfma_f32_16x16x32_bf16 v[104:107], v[204:207], a[24:27], v[104:107]
    v_mfma_f32_16x16x32_bf16 v[108:111], v[204:207], a[28:31], v[108:111]
    s_waitcnt vmcnt(9)
    v_mfma_f32_16x16x32_bf16 v[80:83], v[208:211], a[32:35], v[80:83]
    s_waitcnt vmcnt(8)
    v_mfma_f32_16x16x32_bf16 v[84:87], v[208:211], a[36:39], v[84:87]
    v_mfma_f32_16x16x32_bf16 v[88:91], v[212:215], a[32:35], v[88:91]
    v_mfma_f32_16x16x32_bf16 v[92:95], v[212:215], a[36:39], v[92:95]
    v_mfma_f32_16x16x32_bf16 v[96:99], v[216:219], a[32:35], v[96:99]
    v_mfma_f32_16x16x32_bf16 v[100:103], v[216:219], a[36:39], v[100:103]
    v_mfma_f32_16x16x32_bf16 v[104:107], v[220:223], a[32:35], v[104:107]
    v_mfma_f32_16x16x32_bf16 v[108:111], v[220:223], a[36:39], v[108:111]
    s_waitcnt vmcnt(7)
    v_mfma_f32_16x16x32_bf16 v[40:43], v[236:239], a[40:43], v[40:43]
    s_waitcnt vmcnt(6)
    v_mfma_f32_16x16x32_bf16 v[44:47], v[236:239], a[44:47], v[44:47]
    s_waitcnt vmcnt(5)
    v_mfma_f32_16x16x32_bf16 v[40:43], v[252:255], a[48:51], v[40:43]
    s_waitcnt vmcnt(4)
    v_mfma_f32_16x16x32_bf16 v[44:47], v[252:255], a[52:55], v[44:47]
    v_mfma_f32_16x16x32_bf16 v[32:35], v[232:235], a[40:43], v[32:35]
    s_nop 1
    v_mfma_f32_16x16x32_bf16 v[36:39], v[232:235], a[44:47], v[36:39]
    s_nop 1
    v_mfma_f32_16x16x32_bf16 v[32:35], v[248:251], a[48:51], v[32:35]
    ds_write_b128 v74, v[40:43] offset:0
    v_mfma_f32_16x16x32_bf16 v[36:39], v[248:251], a[52:55], v[36:39]
    ds_write_b128 v74, v[44:47] offset:1024
    v_mfma_f32_16x16x32_bf16 v[24:27], v[228:231], a[40:43], v[24:27]
    s_nop 1
    v_mfma_f32_16x16x32_bf16 v[28:31], v[228:231], a[44:47], v[28:31]
    s_nop 1
    v_mfma_f32_16x16x32_bf16 v[24:27], v[244:247], a[48:51], v[24:27]
    ds_write_b128 v73, v[32:35] offset:0
    v_mfma_f32_16x16x32_bf16 v[28:31], v[244:247], a[52:55], v[28:31]
    ds_write_b128 v73, v[36:39] offset:1024
    v_mfma_f32_16x16x32_bf16 v[16:19], v[224:227], a[40:43], v[16:19]
    s_nop 1
    v_mfma_f32_16x16x32_bf16 v[20:23], v[224:227], a[44:47], v[20:23]
    s_nop 1
    v_mfma_f32_16x16x32_bf16 v[16:19], v[240:243], a[48:51], v[16:19]
    ds_write_b128 v72, v[24:27] offset:0
    v_mfma_f32_16x16x32_bf16 v[20:23], v[240:243], a[52:55], v[20:23]
    ds_write_b128 v72, v[28:31] offset:1024
    s_waitcnt vmcnt(3)
    v_mfma_f32_16x16x32_bf16 v[104:107], v[236:239], a[56:59], v[104:107]
    s_nop 1
    s_waitcnt vmcnt(2)
    v_mfma_f32_16x16x32_bf16 v[108:111], v[236:239], a[60:63], v[108:111]
    s_nop 1
    s_waitcnt vmcnt(1)
    v_mfma_f32_16x16x32_bf16 v[104:107], v[252:255], a[64:67], v[104:107]
    v_add_f32 v16, v16, v48
    v_add_f32 v17, v17, v49
    s_waitcnt vmcnt(0)
    v_mfma_f32_16x16x32_bf16 v[108:111], v[252:255], a[68:71], v[108:111]
    s_waitcnt lgkmcnt(0)
    s_barrier
    v_mfma_f32_16x16x32_bf16 v[96:99], v[232:235], a[56:59], v[96:99]
    ds_read_b128 v[24:27], v75 offset:0
    ds_read_b128 v[32:35], v75 offset:2048
    v_mfma_f32_16x16x32_bf16 v[100:103], v[232:235], a[60:63], v[100:103]
    ds_read_b128 v[40:43], v75 offset:4096
    ds_read_b128 v[28:31], v75 offset:1024
    v_mfma_f32_16x16x32_bf16 v[96:99], v[248:251], a[64:67], v[96:99]
    ds_write_b128 v74, v[104:107] offset:24576
    v_mfma_f32_16x16x32_bf16 v[100:103], v[248:251], a[68:71], v[100:103]
    ds_write_b128 v74, v[108:111] offset:25600
    v_mfma_f32_16x16x32_bf16 v[88:91], v[228:231], a[56:59], v[88:91]
    ds_read_b128 v[36:39], v75 offset:3072
    ds_read_b128 v[44:47], v75 offset:5120
    v_mfma_f32_16x16x32_bf16 v[92:95], v[228:231], a[60:63], v[92:95]
    v_add_f32 v18, v18, v50
    v_add_f32 v19, v19, v51
    v_mfma_f32_16x16x32_bf16 v[88:91], v[244:247], a[64:67], v[88:91]
    ds_write_b128 v73, v[96:99] offset:24576
    v_mfma_f32_16x16x32_bf16 v[92:95], v[244:247], a[68:71], v[92:95]
    ds_write_b128 v73, v[100:103] offset:25600
    v_mfma_f32_16x16x32_bf16 v[80:83], v[224:227], a[56:59], v[80:83]
    v_add_f32 v20, v20, v52
    v_add_f32 v21, v21, v53
    v_mfma_f32_16x16x32_bf16 v[84:87], v[224:227], a[60:63], v[84:87]
    v_add_f32 v22, v22, v54
    v_add_f32 v23, v23, v55
    v_mfma_f32_16x16x32_bf16 v[80:83], v[240:243], a[64:67], v[80:83]
    ds_write_b128 v72, v[88:91] offset:24576
    v_mfma_f32_16x16x32_bf16 v[84:87], v[240:243], a[68:71], v[84:87]
    ds_write_b128 v72, v[92:95] offset:25600
    s_waitcnt lgkmcnt(4)
    v_pk_add_f32 v[24:25], v[24:25], v[32:33]
    v_pk_add_f32 v[26:27], v[26:27], v[34:35]
    v_pk_add_f32 v[16:17], v[16:17], v[40:41]
    v_pk_add_f32 v[18:19], v[18:19], v[42:43]
    v_pk_add_f32 v[16:17], v[16:17], v[24:25]
    v_pk_add_f32 v[18:19], v[18:19], v[26:27]
    v_cvt_pk_bf16_f32 v112, v16, v17
    v_cvt_pk_bf16_f32 v113, v18, v19
    s_waitcnt lgkmcnt(0)
L_pad6:
    s_cbranch_execz L_back1
    s_barrier
    ds_read_b128 v[88:91], v75 offset:24576
    ds_read_b128 v[96:99], v75 offset:26624
    ds_read_b128 v[104:107], v75 offset:28672
    ds_read_b128 v[92:95], v75 offset:25600
    ds_read_b128 v[100:103], v75 offset:27648
    ds_read_b128 v[108:111], v75 offset:29696
    v_pk_add_f32 v[28:29], v[28:29], v[36:37]
    v_pk_add_f32 v[30:31], v[30:31], v[38:39]
    v_pk_add_f32 v[20:21], v[20:21], v[44:45]
    v_pk_add_f32 v[22:23], v[22:23], v[46:47]
    v_pk_add_f32 v[20:21], v[20:21], v[28:29]
    v_pk_add_f32 v[22:23], v[22:23], v[30:31]
    v_cvt_pk_bf16_f32 v114, v20, v21
    v_cvt_pk_bf16_f32 v115, v22, v23
    v_add_f32 v80, v80, v56
    v_add_f32 v81, v81, v57
    v_permlane32_swap_b32 v112, v114
    v_permlane32_swap_b32 v113, v115
    global_store_dwordx4 v76, v[112:115], s[22:23]
    v_add_f32 v82, v82, v58
    v_add_f32 v83, v83, v59
    v_add_f32 v84, v84, v60
    v_add_f32 v85, v85, v61
    v_add_f32 v86, v86, v62
    v_add_f32 v87, v87, v63
    s_waitcnt lgkmcnt(3)
    v_pk_add_f32 v[88:89], v[88:89], v[96:97]
    v_pk_add_f32 v[90:91], v[90:91], v[98:99]
    v_pk_add_f32 v[80:81], v[80:81], v[104:105]
    v_pk_add_f32 v[82:83], v[82:83], v[106:107]
    v_pk_add_f32 v[80:81], v[80:81], v[88:89]
    v_pk_add_f32 v[82:83], v[82:83], v[90:91]
    v_cvt_pk_bf16_f32 v116, v80, v81
    v_cvt_pk_bf16_f32 v117, v82, v83
    s_waitcnt lgkmcnt(0)
    v_pk_add_f32 v[92:93], v[92:93], v[100:101]
    v_pk_add_f32 v[94:95], v[94:95], v[102:103]
    v_pk_add_f32 v[84:85], v[84:85], v[108:109]
    v_pk_add_f32 v[86:87], v[86:87], v[110:111]
    v_pk_add_f32 v[84:85], v[84:85], v[92:93]
    v_pk_add_f32 v[86:87], v[86:87], v[94:95]
    v_cvt_pk_bf16_f32 v118, v84, v85
    v_cvt_pk_bf16_f32 v119, v86, v87
    s_nop 0
    v_permlane32_swap_b32 v116, v118
    v_permlane32_swap_b32 v117, v119
    global_store_dwordx4 v77, v[116:119], s[22:23]
L_done:
L_exit:
    s_endpgm
L_arr_spin:
    s_mov_b32 s64, 16777216
L_arr_spin2:
    ds_read_b32 v14, v220 offset:256
    s_waitcnt lgkmcnt(0)
    v_cmp_ne_u32 vcc, 4, v14
    s_cbranch_vccz L_arr_ok
    s_sub_u32 s64, s64, 1
    s_cbranch_scc0 L_arr_spin2
    s_branch L_arr_ok
L_kv2_spin:
    s_mov_b32 s3, 262144
L_kv2_spin2:
    global_load_dwordx2 v[14:15], v4, s[26:27] sc1
    s_waitcnt vmcnt(0)
    v_cmp_ne_u64 vcc, s[68:69], v[14:15]
    s_cbranch_vccz L_kv2_out
    s_sub_u32 s3, s3, 1
    s_cbranch_scc0 L_kv2_spin2
L_kv2_out:
    s_branch L_kv2_ok
L_fp_spin:
    s_mov_b32 s3, 262144
L_fp_spin2:
    s_sleep 4
    global_load_dwordx4 v[248:251], v12, s[26:27] offset:0 sc1
    global_load_dwordx4 v[252:255], v12, s[26:27] offset:1024 sc1
    s_waitcnt vmcnt(0)
    v_cmp_ne_u64 vcc, s[68:69], v[248:249]
    v_cmp_ne_u64 s[64:65], s[68:69], v[250:251]
    s_or_b64 vcc, vcc, s[64:65]
    v_cmp_ne_u64 s[64:65], s[68:69], v[252:253]
    s_or_b64 vcc, vcc, s[64:65]
    v_cmp_ne_u64 s[64:65], s[68:69], v[254:255]
    s_or_b64 vcc, vcc, s[64:65]
    s_cbranch_vccz L_fp_out
    s_sub_u32 s3, s3, 1
    s_cbranch_scc0 L_fp_spin2
L_fp_out:
    s_branch L_fp_ok
L_kv_spin:
    s_mov_b32 s3, 262144
L_kv_spin2:
    global_load_dwordx2 v[14:15], v63, s[26:27] sc1
    s_waitcnt vmcnt(0)
    v_cmp_ne_u64 vcc, s[68:69], v[14:15]
    s_cbranch_vccz L_kv_out
    s_sub_u32 s3, s3, 1
    s_cbranch_scc0 L_kv_spin2
L_kv_out:
    s_branch L_kv_ok
L_exact:
    s_waitcnt vmcnt(0) lgkmcnt(0)
    s_barrier
    v_bfe_u32 v57, v0, 3, 2
    v_mul_u32_u24 v57, 7, v57
    v_lshrrev_b32 v53, 5, v0
    v_add_u32 v52, v57, v53
    v_and_b32 v53, 7, v0
    v_lshlrev_b32 v53, 5, v53
    s_add_u32 s3, s28, 0
    s_and_b32 s3, s3, 3
    s_mul_i32 s3, s3, 1792
    s_add_u32 s62, s3, 151552
    s_add_u32 s3, s28, 1
    s_and_b32 s3, s3, 3
    s_mul_i32 s3, s3, 1792
    s_add_u32 s63, s3, 151552
    s_add_u32 s3, s28, 2
    s_and_b32 s3, s3, 3
    s_mul_i32 s3, s3, 1792
    s_add_u32 s64, s3, 151552
    s_add_u32 s3, s28, 3
    s_and_b32 s3, s3, 3
    s_mul_i32 s3, s3, 1792
    s_add_u32 s65, s3, 151552
    v_add_u32 v54, 0, v52
    v_lshrrev_b32 v55, 2, v54
    v_lshl_add_u32 v55, v55, 8, v53
    v_and_b32 v56, 1, v54
    v_lshl_add_u32 v55, v56, 4, v55
    v_bfe_u32 v56, v54, 1, 1
    v_lshl_add_u32 v55, v56, 3, v55
    v_add_u32 v128, s62, v55
    v_add_u32 v136, s63, v55
    v_add_u32 v144, s64, v55
    v_add_u32 v152, s65, v55
    v_add_u32 v54, 2, v52
    v_lshrrev_b32 v55, 2, v54
    v_lshl_add_u32 v55, v55, 8, v53
    v_and_b32 v56, 1, v54
    v_lshl_add_u32 v55, v56, 4, v55
    v_bfe_u32 v56, v54, 1, 1
    v_lshl_add_u32 v55, v56, 3, v55
    v_add_u32 v130, s62, v55
    v_add_u32 v138, s63, v55
    v_add_u32 v146, s64, v55
    v_add_u32 v154, s65, v55
    v_add_u32 v54, 4, v52
    v_lshrrev_b32 v55, 2, v54
    v_lshl_add_u32 v55, v55, 8, v53
    v_and_b32 v56, 1, v54
    v_lshl_add_u32 v55, v56, 4, v55
    v_bfe_u32 v56, v54, 1, 1
    v_lshl_add_u32 v55, v56, 3, v55
    v_add_u32 v132, s62, v55
    v_add_u32 v140, s63, v55
    v_add_u32 v148, s64, v55
    v_add_u32 v156, s65, v55
    v_add_u32 v54, 6, v57
    v_lshrrev_b32 v55, 2, v54
    v_lshl_add_u32 v55, v55, 8, v53
    v_and_b32 v56, 1, v54
    v_lshl_add_u32 v55, v56, 4, v55
    v_bfe_u32 v56, v54, 1, 1
    v_lshl_add_u32 v55, v56, 3, v55
    v_add_u32 v134, s62, v55
    v_add_u32 v142, s63, v55
    v_add_u32 v150, s64, v55
    v_add_u32 v158, s65, v55
    ds_read_b64 v[136:137], v136
    ds_read_b64 v[138:139], v138
    ds_read_b64 v[140:141], v140
    ds_read_b64 v[142:143], v142
    ds_read_b64 v[144:145], v144
    ds_read_b64 v[146:147], v146
    ds_read_b64 v[148:149], v148
    ds_read_b64 v[150:151], v150
    ds_read_b64 v[152:153], v152
    ds_read_b64 v[154:155], v154
    ds_read_b64 v[156:157], v156
    ds_read_b64 v[158:159], v158
    ds_read_b64 v[128:129], v128
    ds_read_b64 v[130:131], v130
    ds_read_b64 v[132:133], v132
    ds_read_b64 v[134:135], v134
    s_waitcnt lgkmcnt(0)
    v_mov_b32 v48, 0xff800000
    v_mov_b32 v49, 0xff800000
    v_mov_b32 v50, 0xff800000
    v_mov_b32 v51, 0xff800000
    s_mov_b64 s[36:37], s[38:39]
    s_mov_b32 s24, 16
L_exact_max:
    global_load_dwordx4 v[32:35], v1, s[36:37] offset:-4096 sc1
    global_load_dwordx4 v[36:39], v1, s[36:37] offset:-3072 sc1
    s_add_u32 s36, s36, 4096
    s_addc_u32 s37, s37, 0
    s_waitcnt vmcnt(0)
    v_mfma_f32_32x32x16_bf16 v[16:31], v[32:35], v[128:131], 0
    v_mfma_f32_32x32x16_bf16 v[16:31], v[36:39], v[132:135], v[16:31]
    s_nop 11
    v_max3_f32 v48, v48, v16, v17
    v_max3_f32 v48, v48, v18, v19
    v_max3_f32 v48, v48, v20, v21
    v_max3_f32 v48, v48, v22, v23
    v_max3_f32 v48, v48, v24, v25
    v_max3_f32 v48, v48, v26, v27
    v_max3_f32 v48, v48, v28, v29
    v_max3_f32 v48, v48, v30, v31
    v_mfma_f32_32x32x16_bf16 v[16:31], v[32:35], v[136:139], 0
    v_mfma_f32_32x32x16_bf16 v[16:31], v[36:39], v[140:143], v[16:31]
    s_nop 11
    v_max3_f32 v49, v49, v16, v17
    v_max3_f32 v49, v49, v18, v19
    v_max3_f32 v49, v49, v20, v21
    v_max3_f32 v49, v49, v22, v23
    v_max3_f32 v49, v49, v24, v25
    v_max3_f32 v49, v49, v26, v27
    v_max3_f32 v49, v49, v28, v29
    v_max3_f32 v49, v49, v30, v31
    v_mfma_f32_32x32x16_bf16 v[16:31], v[32:35], v[144:147], 0
    v_mfma_f32_32x32x16_bf16 v[16:31], v[36:39], v[148:151], v[16:31]
    s_nop 11
    v_max3_f32 v50, v50, v16, v17
    v_max3_f32 v50, v50, v18, v19
    v_max3_f32 v50, v50, v20, v21
    v_max3_f32 v50, v50, v22, v23
    v_max3_f32 v50, v50, v24, v25
    v_max3_f32 v50, v50, v26, v27
    v_max3_f32 v50, v50, v28, v29
    v_max3_f32 v50, v50, v30, v31
    v_mfma_f32_32x32x16_bf16 v[16:31], v[32:35], v[152:155], 0
    v_mfma_f32_32x32x16_bf16 v[16:31], v[36:39], v[156:159], v[16:31]
    s_nop 11
    v_max3_f32 v51, v51, v16, v17
    v_max3_f32 v51, v51, v18, v19
    v_max3_f32 v51, v51, v20, v21
    v_max3_f32 v51, v51, v22, v23
    v_max3_f32 v51, v51, v24, v25
    v_max3_f32 v51, v51, v26, v27
    v_max3_f32 v51, v51, v28, v29
    v_max3_f32 v51, v51, v30, v31
    s_nop 15
    s_sub_u32 s24, s24, 1
    s_cmp_lg_u32 s24, 0
    s_cbranch_scc1 L_exact_max
    v_and_b32 v53, 31, v0
    v_lshlrev_b32 v53, 4, v53
    v_mov_b32 v52, v48
    s_nop 1
    v_permlane32_swap_b32 v48, v52
    v_max_f32 v48, v48, v52
    s_add_u32 s3, s28, 0
    s_and_b32 s3, s3, 3
    s_lshl_b32 s3, s3, 9
    s_add_u32 s3, s3, 143360
    v_add_u32 v54, s3, v53
    s_lshl_b32 s3, s28, 2
    v_add_u32 v58, s3, v54
    ds_write_b32 v58, v48
    v_mov_b32 v52, v49
    s_nop 1
    v_permlane32_swap_b32 v49, v52
    v_max_f32 v49, v49, v52
    s_add_u32 s3, s28, 1
    s_and_b32 s3, s3, 3
    s_lshl_b32 s3, s3, 9
    s_add_u32 s3, s3, 143360
    v_add_u32 v55, s3, v53
    s_lshl_b32 s3, s28, 2
    v_add_u32 v58, s3, v55
    ds_write_b32 v58, v49
    v_mov_b32 v52, v50
    s_nop 1
    v_permlane32_swap_b32 v50, v52
    v_max_f32 v50, v50, v52
    s_add_u32 s3, s28, 2
    s_and_b32 s3, s3, 3
    s_lshl_b32 s3, s3, 9
    s_add_u32 s3, s3, 143360
    v_add_u32 v56, s3, v53
    s_lshl_b32 s3, s28, 2
    v_add_u32 v58, s3, v56
    ds_write_b32 v58, v50
    v_mov_b32 v52, v51
    s_nop 1
    v_permlane32_swap_b32 v51, v52
    v_max_f32 v51, v51, v52
    s_add_u32 s3, s28, 3
    s_and_b32 s3, s3, 3
    s_lshl_b32 s3, s3, 9
    s_add_u32 s3, s3, 143360
    v_add_u32 v57, s3, v53
    s_lshl_b32 s3, s28, 2
    v_add_u32 v58, s3, v57
    ds_write_b32 v58, v51
    s_waitcnt lgkmcnt(0)
    s_barrier
    ds_read_b128 v[60:63], v54
    s_waitcnt lgkmcnt(0)
    v_max3_f32 v48, v60, v61, v62
    v_max_f32 v48, v48, v63
    ds_read_b128 v[60:63], v55
    s_waitcnt lgkmcnt(0)
    v_max3_f32 v49, v60, v61, v62
    v_max_f32 v49, v49, v63
    ds_read_b128 v[60:63], v56
    s_waitcnt lgkmcnt(0)
    v_max3_f32 v50, v60, v61, v62
    v_max_f32 v50, v50, v63
    ds_read_b128 v[60:63], v57
    s_waitcnt lgkmcnt(0)
    v_max3_f32 v51, v60, v61, v62
    v_max_f32 v51, v51, v63
    v_mov_b32 v52, 0xdddddddd
    v_mov_b64 v[64:65], 0
    v_mov_b64 v[66:67], 0
    v_mov_b64 v[68:69], 0
    v_mov_b64 v[70:71], 0
    v_mov_b64 v[72:73], 0
    v_mov_b64 v[74:75], 0
    v_mov_b64 v[76:77], 0
    v_mov_b64 v[78:79], 0
    v_mov_b64 v[80:81], 0
    v_mov_b64 v[82:83], 0
    v_mov_b64 v[84:85], 0
    v_mov_b64 v[86:87], 0
    v_mov_b64 v[88:89], 0
    v_mov_b64 v[90:91], 0
    v_mov_b64 v[92:93], 0
    v_mov_b64 v[94:95], 0
    v_mov_b64 v[96:97], 0
    v_mov_b64 v[98:99], 0
    v_mov_b64 v[100:101], 0
    v_mov_b64 v[102:103], 0
    v_mov_b64 v[104:105], 0
    v_mov_b64 v[106:107], 0
    v_mov_b64 v[108:109], 0
    v_mov_b64 v[110:111], 0
    v_mov_b64 v[112:113], 0
    v_mov_b64 v[114:115], 0
    v_mov_b64 v[116:117], 0
    v_mov_b64 v[118:119], 0
    v_mov_b64 v[120:121], 0
    v_mov_b64 v[122:123], 0
    v_mov_b64 v[124:125], 0
    v_mov_b64 v[126:127], 0
    s_mov_b64 s[36:37], s[38:39]
    s_mov_b32 s24, 16
L_exact_pv:
    global_load_dwordx4 v[32:35], v1, s[36:37] offset:-4096 sc1
    global_load_dwordx4 v[36:39], v1, s[36:37] offset:-3072 sc1
    global_load_dwordx4 v[40:43], v1, s[36:37] offset:-2048 sc1
    global_load_dwordx4 v[44:47], v1, s[36:37] offset:-1024 sc1
    s_add_u32 s36, s36, 4096
    s_addc_u32 s37, s37, 0
    s_waitcnt vmcnt(0)
    v_mfma_f32_32x32x16_bf16 v[16:31], v[32:35], v[128:131], 0
    v_mfma_f32_32x32x16_bf16 v[16:31], v[36:39], v[132:135], v[16:31]
    s_nop 11
    v_sub_f32 v16, v16, v48
    v_sub_f32 v17, v17, v48
    v_sub_f32 v18, v18, v48
    v_sub_f32 v19, v19, v48
    v_sub_f32 v20, v20, v48
    v_sub_f32 v21, v21, v48
    v_sub_f32 v22, v22, v48
    v_sub_f32 v23, v23, v48
    v_sub_f32 v24, v24, v48
    v_sub_f32 v25, v25, v48
    v_sub_f32 v26, v26, v48
    v_sub_f32 v27, v27, v48
    v_sub_f32 v28, v28, v48
    v_sub_f32 v29, v29, v48
    v_sub_f32 v30, v30, v48
    v_sub_f32 v31, v31, v48
    v_exp_f32 v16, v16
    v_exp_f32 v17, v17
    v_exp_f32 v18, v18
    v_exp_f32 v19, v19
    v_exp_f32 v20, v20
    v_exp_f32 v21, v21
    v_exp_f32 v22, v22
    v_exp_f32 v23, v23
    v_exp_f32 v24, v24
    v_exp_f32 v25, v25
    v_exp_f32 v26, v26
    v_exp_f32 v27, v27
    v_exp_f32 v28, v28
    v_exp_f32 v29, v29
    v_exp_f32 v30, v30
    v_exp_f32 v31, v31
    v_smfmac_f32_32x32x32_bf16 v[64:79], v[40:43], v[16:23], v52
    s_nop 0
    v_smfmac_f32_32x32x32_bf16 v[64:79], v[44:47], v[24:31], v52
    v_mfma_f32_32x32x16_bf16 v[16:31], v[32:35], v[136:139], 0
    v_mfma_f32_32x32x16_bf16 v[16:31], v[36:39], v[140:143], v[16:31]
    s_nop 11
    v_sub_f32 v16, v16, v49
    v_sub_f32 v17, v17, v49
    v_sub_f32 v18, v18, v49
    v_sub_f32 v19, v19, v49
    v_sub_f32 v20, v20, v49
    v_sub_f32 v21, v21, v49
    v_sub_f32 v22, v22, v49
    v_sub_f32 v23, v23, v49
    v_sub_f32 v24, v24, v49
    v_sub_f32 v25, v25, v49
    v_sub_f32 v26, v26, v49
    v_sub_f32 v27, v27, v49
    v_sub_f32 v28, v28, v49
    v_sub_f32 v29, v29, v49
    v_sub_f32 v30, v30, v49
    v_sub_f32 v31, v31, v49
    v_exp_f32 v16, v16
    v_exp_f32 v17, v17
    v_exp_f32 v18, v18
    v_exp_f32 v19, v19
    v_exp_f32 v20, v20
    v_exp_f32 v21, v21
    v_exp_f32 v22, v22
    v_exp_f32 v23, v23
    v_exp_f32 v24, v24
    v_exp_f32 v25, v25
    v_exp_f32 v26, v26
    v_exp_f32 v27, v27
    v_exp_f32 v28, v28
    v_exp_f32 v29, v29
    v_exp_f32 v30, v30
    v_exp_f32 v31, v31
    v_smfmac_f32_32x32x32_bf16 v[80:95], v[40:43], v[16:23], v52
    s_nop 0
    v_smfmac_f32_32x32x32_bf16 v[80:95], v[44:47], v[24:31], v52
    v_mfma_f32_32x32x16_bf16 v[16:31], v[32:35], v[144:147], 0
    v_mfma_f32_32x32x16_bf16 v[16:31], v[36:39], v[148:151], v[16:31]
    s_nop 11
    v_sub_f32 v16, v16, v50
    v_sub_f32 v17, v17, v50
    v_sub_f32 v18, v18, v50
    v_sub_f32 v19, v19, v50
    v_sub_f32 v20, v20, v50
    v_sub_f32 v21, v21, v50
    v_sub_f32 v22, v22, v50
    v_sub_f32 v23, v23, v50
    v_sub_f32 v24, v24, v50
    v_sub_f32 v25, v25, v50
    v_sub_f32 v26, v26, v50
    v_sub_f32 v27, v27, v50
    v_sub_f32 v28, v28, v50
    v_sub_f32 v29, v29, v50
    v_sub_f32 v30, v30, v50
    v_sub_f32 v31, v31, v50
    v_exp_f32 v16, v16
    v_exp_f32 v17, v17
    v_exp_f32 v18, v18
    v_exp_f32 v19, v19
    v_exp_f32 v20, v20
    v_exp_f32 v21, v21
    v_exp_f32 v22, v22
    v_exp_f32 v23, v23
    v_exp_f32 v24, v24
    v_exp_f32 v25, v25
    v_exp_f32 v26, v26
    v_exp_f32 v27, v27
    v_exp_f32 v28, v28
    v_exp_f32 v29, v29
    v_exp_f32 v30, v30
    v_exp_f32 v31, v31
    v_smfmac_f32_32x32x32_bf16 v[96:111], v[40:43], v[16:23], v52
    s_nop 0
    v_smfmac_f32_32x32x32_bf16 v[96:111], v[44:47], v[24:31], v52
    v_mfma_f32_32x32x16_bf16 v[16:31], v[32:35], v[152:155], 0
    v_mfma_f32_32x32x16_bf16 v[16:31], v[36:39], v[156:159], v[16:31]
    s_nop 11
    v_sub_f32 v16, v16, v51
    v_sub_f32 v17, v17, v51
    v_sub_f32 v18, v18, v51
    v_sub_f32 v19, v19, v51
    v_sub_f32 v20, v20, v51
    v_sub_f32 v21, v21, v51
    v_sub_f32 v22, v22, v51
    v_sub_f32 v23, v23, v51
    v_sub_f32 v24, v24, v51
    v_sub_f32 v25, v25, v51
    v_sub_f32 v26, v26, v51
    v_sub_f32 v27, v27, v51
    v_sub_f32 v28, v28, v51
    v_sub_f32 v29, v29, v51
    v_sub_f32 v30, v30, v51
    v_sub_f32 v31, v31, v51
    v_exp_f32 v16, v16
    v_exp_f32 v17, v17
    v_exp_f32 v18, v18
    v_exp_f32 v19, v19
    v_exp_f32 v20, v20
    v_exp_f32 v21, v21
    v_exp_f32 v22, v22
    v_exp_f32 v23, v23
    v_exp_f32 v24, v24
    v_exp_f32 v25, v25
    v_exp_f32 v26, v26
    v_exp_f32 v27, v27
    v_exp_f32 v28, v28
    v_exp_f32 v29, v29
    v_exp_f32 v30, v30
    v_exp_f32 v31, v31
    v_smfmac_f32_32x32x32_bf16 v[112:127], v[40:43], v[16:23], v52
    s_nop 0
    v_smfmac_f32_32x32x32_bf16 v[112:127], v[44:47], v[24:31], v52
    s_nop 15
    s_sub_u32 s24, s24, 1
    s_cmp_lg_u32 s24, 0
    s_cbranch_scc1 L_exact_pv
    ds_write_b128 v6, v[80:83] offset:0
    ds_write_b128 v6, v[84:87] offset:1024
    ds_write_b128 v6, v[88:91] offset:2048
    ds_write_b128 v6, v[92:95] offset:3072
    ds_write_b128 v7, v[96:99] offset:0
    ds_write_b128 v7, v[100:103] offset:1024
    ds_write_b128 v7, v[104:107] offset:2048
    ds_write_b128 v7, v[108:111] offset:3072
    ds_write_b128 v8, v[112:115] offset:0
    ds_write_b128 v8, v[116:119] offset:1024
    ds_write_b128 v8, v[120:123] offset:2048
    ds_write_b128 v8, v[124:127] offset:3072
    s_waitcnt lgkmcnt(0)
    s_barrier
    s_mul_i32 s3, s28, 98*1024
    s_add_u32 s24, s3, 2359296
    s_add_u32 s3, s24, 65536
    v_add_u32 v4, s3, v1
    global_load_dwordx4 v[136:139], v4, s[26:27] sc1
    s_add_u32 s3, s24, 66560
    v_add_u32 v4, s3, v1
    global_load_dwordx4 v[140:143], v4, s[26:27] sc1
    s_add_u32 s3, s24, 67584
    v_add_u32 v4, s3, v1
    global_load_dwordx4 v[144:147], v4, s[26:27] sc1
    s_add_u32 s3, s24, 68608
    v_add_u32 v4, s3, v1
    global_load_dwordx4 v[148:151], v4, s[26:27] sc1
    s_add_u32 s3, s24, 69632
    v_add_u32 v4, s3, v1
    global_load_dwordx4 v[152:155], v4, s[26:27] sc1
    s_add_u32 s3, s24, 70656
    v_add_u32 v4, s3, v1
    global_load_dwordx4 v[156:159], v4, s[26:27] sc1
    s_add_u32 s3, s24, 83968
    v_add_u32 v4, s3, v1
    global_load_dwordx4 v[128:131], v4, s[26:27] sc1
    s_add_u32 s3, s24, 84992
    v_add_u32 v4, s3, v1
    global_load_dwordx4 v[132:135], v4, s[26:27] sc1
    s_add_u32 s3, s24, 94208
    v_add_u32 v4, s3, v1
    global_load_dwordx4 v[16:19], v4, s[26:27] sc1
    s_add_u32 s3, s24, 95232
    v_add_u32 v4, s3, v1
    global_load_dwordx4 v[20:23], v4, s[26:27] sc1
    s_add_u32 s3, s24, 96256
    v_add_u32 v4, s3, v1
    global_load_dwordx4 v[24:27], v4, s[26:27] sc1
    s_add_u32 s3, s24, 97280
    v_add_u32 v4, s3, v1
    global_load_dwordx4 v[28:31], v4, s[26:27] sc1
    s_add_u32 s3, s24, 98304
    v_add_u32 v4, s3, v1
    global_load_dwordx4 v[32:35], v4, s[26:27] sc1
    s_add_u32 s3, s24, 99328
    v_add_u32 v4, s3, v1
    global_load_dwordx4 v[36:39], v4, s[26:27] sc1
    ds_read_b128 v[92:95], v9 offset:3072
    ds_read_b128 v[108:111], v9 offset:7168
    ds_read_b128 v[124:127], v9 offset:11264
    ds_read_b128 v[80:83], v9 offset:0
    ds_read_b128 v[96:99], v9 offset:4096
    ds_read_b128 v[112:115], v9 offset:8192
    ds_read_b128 v[84:87], v9 offset:1024
    ds_read_b128 v[100:103], v9 offset:5120
    ds_read_b128 v[116:119], v9 offset:9216
    ds_read_b128 v[88:91], v9 offset:2048
    ds_read_b128 v[104:107], v9 offset:6144
    ds_read_b128 v[120:123], v9 offset:10240
    s_waitcnt lgkmcnt(9)
    v_pk_add_f32 v[108:109], v[108:109], v[124:125]
    v_pk_add_f32 v[110:111], v[110:111], v[126:127]
    v_pk_add_f32 v[92:93], v[92:93], v[108:109]
    v_pk_add_f32 v[94:95], v[94:95], v[110:111]
    v_pk_add_f32 v[76:77], v[76:77], v[92:93]
    v_pk_add_f32 v[78:79], v[78:79], v[94:95]
    v_mov_b32 v14, v76
    v_mov_b32 v15, v76
    s_waitcnt lgkmcnt(6)
    v_pk_add_f32 v[96:97], v[96:97], v[112:113]
    v_pk_add_f32 v[98:99], v[98:99], v[114:115]
    v_permlane32_swap_b32 v14, v15
    v_pk_add_f32 v[64:65], v[64:65], v[80:81]
    v_pk_add_f32 v[66:67], v[66:67], v[82:83]
    v_rcp_f32 v14, v15
    v_pk_add_f32 v[64:65], v[64:65], v[96:97]
    v_pk_add_f32 v[66:67], v[66:67], v[98:99]
    s_waitcnt lgkmcnt(0)
    v_pk_add_f32 v[100:101], v[100:101], v[116:117]
    v_pk_add_f32 v[102:103], v[102:103], v[118:119]
    v_pk_add_f32 v[68:69], v[68:69], v[84:85]
    v_pk_add_f32 v[70:71], v[70:71], v[86:87]
    v_pk_add_f32 v[68:69], v[68:69], v[100:101]
    v_pk_add_f32 v[70:71], v[70:71], v[102:103]
    v_pk_add_f32 v[104:105], v[104:105], v[120:121]
    v_pk_add_f32 v[106:107], v[106:107], v[122:123]
    v_pk_add_f32 v[72:73], v[72:73], v[88:89]
    v_pk_add_f32 v[74:75], v[74:75], v[90:91]
    v_pk_add_f32 v[72:73], v[72:73], v[104:105]
    v_pk_add_f32 v[74:75], v[74:75], v[106:107]
    v_pk_mul_f32 v[76:77], v[14:15], v[76:77] op_sel_hi:[0,1]
    v_pk_mul_f32 v[78:79], v[14:15], v[78:79] op_sel_hi:[0,1]
    v_cvt_pk_bf16_f32 v86, v76, v77
    v_cvt_pk_bf16_f32 v87, v78, v79
    ds_write_b64 v3, v[86:87]
    v_pk_mul_f32 v[64:65], v[14:15], v[64:65] op_sel_hi:[0,1]
    v_pk_mul_f32 v[66:67], v[14:15], v[66:67] op_sel_hi:[0,1]
    v_cvt_pk_bf16_f32 v80, v64, v65
    v_cvt_pk_bf16_f32 v81, v66, v67
    ds_write_b64 v2, v[80:81] offset:0
    v_pk_mul_f32 v[68:69], v[14:15], v[68:69] op_sel_hi:[0,1]
    v_pk_mul_f32 v[70:71], v[14:15], v[70:71] op_sel_hi:[0,1]
    v_cvt_pk_bf16_f32 v82, v68, v69
    v_cvt_pk_bf16_f32 v83, v70, v71
    ds_write_b64 v2, v[82:83] offset:16
    v_pk_mul_f32 v[72:73], v[14:15], v[72:73] op_sel_hi:[0,1]
    v_pk_mul_f32 v[74:75], v[14:15], v[74:75] op_sel_hi:[0,1]
    v_cvt_pk_bf16_f32 v84, v72, v73
    v_cvt_pk_bf16_f32 v85, v74, v75
    ds_write_b64 v2, v[84:85] offset:32
    v_mov_b64 v[96:97], 0
    v_mov_b64 v[98:99], 0
    v_mov_b64 v[100:101], 0
    v_mov_b64 v[102:103], 0
    v_mov_b64 v[104:105], 0
    v_mov_b64 v[106:107], 0
    v_mov_b64 v[108:109], 0
    v_mov_b64 v[110:111], 0
    v_mov_b64 v[112:113], 0
    v_mov_b64 v[114:115], 0
    v_mov_b64 v[116:117], 0
    v_mov_b64 v[118:119], 0
    v_mov_b64 v[120:121], 0
    v_mov_b64 v[122:123], 0
    s_waitcnt lgkmcnt(0)
    s_barrier
    ds_read_b128 v[64:67], v10 offset:0
    ds_read_b128 v[68:71], v10 offset:128
    ds_read_b128 v[72:75], v10 offset:256
    ds_read_b128 v[76:79], v10 offset:384
    ds_read_b128 v[80:83], v10 offset:512
    ds_read_b128 v[84:87], v10 offset:640
    ds_read_b128 v[88:91], v10 offset:768
    v_lshlrev_b32 v40, 16, v208
    v_and_b32 v41, 0xffff0000, v208
    v_lshlrev_b32 v42, 16, v209
    v_and_b32 v43, 0xffff0000, v209
    v_lshlrev_b32 v44, 16, v210
    v_and_b32 v45, 0xffff0000, v210
    v_lshlrev_b32 v46, 16, v211
    v_and_b32 v47, 0xffff0000, v211
    v_lshlrev_b32 v48, 16, v212
    v_and_b32 v49, 0xffff0000, v212
    v_lshlrev_b32 v50, 16, v213
    v_and_b32 v51, 0xffff0000, v213
    v_lshlrev_b32 v52, 16, v214
    v_and_b32 v53, 0xffff0000, v214
    v_lshlrev_b32 v54, 16, v215
    v_and_b32 v55, 0xffff0000, v215
    s_waitcnt lgkmcnt(4)
    v_smfmac_f32_16x16x64_bf16 v[96:99], v[64:67], a[0:7], v218
    v_smfmac_f32_16x16x64_bf16 v[96:99], v[68:71], a[56:63], v218
    v_smfmac_f32_16x16x64_bf16 v[96:99], v[72:75], a[112:119], v218
    s_waitcnt lgkmcnt(0)
    v_smfmac_f32_16x16x64_bf16 v[96:99], v[76:79], a[120:127], v218
    v_smfmac_f32_16x16x64_bf16 v[96:99], v[80:83], a[128:135], v218
    v_smfmac_f32_16x16x64_bf16 v[96:99], v[84:87], a[136:143], v218
    v_smfmac_f32_16x16x64_bf16 v[96:99], v[88:91], a[144:151], v218
    v_smfmac_f32_16x16x64_bf16 v[100:103], v[64:67], a[8:15], v218
    v_smfmac_f32_16x16x64_bf16 v[100:103], v[68:71], a[64:71], v218
    v_smfmac_f32_16x16x64_bf16 v[100:103], v[72:75], a[152:159], v218
    v_smfmac_f32_16x16x64_bf16 v[100:103], v[76:79], a[160:167], v218
    v_smfmac_f32_16x16x64_bf16 v[100:103], v[80:83], a[168:175], v218
    s_nop 2
    v_permlane32_swap_b32 v96, v98
    v_smfmac_f32_16x16x64_bf16 v[100:103], v[84:87], a[176:183], v218
    v_permlane32_swap_b32 v97, v99
    v_smfmac_f32_16x16x64_bf16 v[100:103], v[88:91], v[224:231], v218
    v_add_f32 v96, v96, v98
    v_smfmac_f32_16x16x64_bf16 v[104:107], v[64:67], a[16:23], v218
    v_smfmac_f32_16x16x64_bf16 v[104:107], v[68:71], a[72:79], v218
    v_add_f32 v97, v97, v99
    v_smfmac_f32_16x16x64_bf16 v[104:107], v[72:75], v[248:255], v218
    ds_write2_b32 v216, v96, v97 offset0:0 offset1:116
    v_smfmac_f32_16x16x64_bf16 v[104:107], v[76:79], v[232:239], v218
    v_smfmac_f32_16x16x64_bf16 v[104:107], v[80:83], a[240:247], v218
    v_permlane32_swap_b32 v100, v102
    v_smfmac_f32_16x16x64_bf16 v[104:107], v[84:87], v[240:247], v218
    v_permlane32_swap_b32 v101, v103
    v_smfmac_f32_16x16x64_bf16 v[104:107], v[88:91], v[168:175], v218
    v_add_f32 v100, v100, v102
    v_smfmac_f32_16x16x64_bf16 v[108:111], v[64:67], a[24:31], v218
    v_smfmac_f32_16x16x64_bf16 v[108:111], v[68:71], a[80:87], v218
    v_add_f32 v101, v101, v103
    v_smfmac_f32_16x16x64_bf16 v[108:111], v[72:75], v[200:207], v218
    ds_write2_b32 v216, v100, v101 offset0:16 offset1:132
    v_smfmac_f32_16x16x64_bf16 v[108:111], v[76:79], v[176:183], v218
    v_smfmac_f32_16x16x64_bf16 v[108:111], v[80:83], a[232:239], v218
    v_permlane32_swap_b32 v104, v106
    v_smfmac_f32_16x16x64_bf16 v[108:111], v[84:87], a[224:231], v218
    v_permlane32_swap_b32 v105, v107
    v_smfmac_f32_16x16x64_bf16 v[108:111], v[88:91], v[184:191], v218
    v_add_f32 v104, v104, v106
    v_smfmac_f32_16x16x64_bf16 v[112:115], v[64:67], a[32:39], v218
    v_smfmac_f32_16x16x64_bf16 v[112:115], v[68:71], a[88:95], v218
    v_add_f32 v105, v105, v107
    s_waitcnt vmcnt(8)
    v_smfmac_f32_16x16x64_bf16 v[112:115], v[72:75], a[216:223], v218
    ds_write2_b32 v216, v104, v105 offset0:32 offset1:148
    v_smfmac_f32_16x16x64_bf16 v[112:115], v[76:79], a[208:215], v218
    v_smfmac_f32_16x16x64_bf16 v[112:115], v[80:83], v[136:143], v218
    v_permlane32_swap_b32 v108, v110
    v_smfmac_f32_16x16x64_bf16 v[112:115], v[84:87], v[144:151], v218
    v_permlane32_swap_b32 v109, v111
    v_smfmac_f32_16x16x64_bf16 v[112:115], v[88:91], v[152:159], v218
    v_add_f32 v108, v108, v110
    v_smfmac_f32_16x16x64_bf16 v[116:119], v[64:67], a[40:47], v218
    v_smfmac_f32_16x16x64_bf16 v[116:119], v[68:71], a[96:103], v218
    v_add_f32 v109, v109, v111
    v_smfmac_f32_16x16x64_bf16 v[116:119], v[72:75], v[160:167], v218
    ds_write2_b32 v216, v108, v109 offset0:48 offset1:164
    v_smfmac_f32_16x16x64_bf16 v[116:119], v[76:79], a[200:207], v218
    v_smfmac_f32_16x16x64_bf16 v[116:119], v[80:83], v[192:199], v218
    v_permlane32_swap_b32 v112, v114
    s_waitcnt vmcnt(6)
    v_smfmac_f32_16x16x64_bf16 v[116:119], v[84:87], a[248:255], v218
    v_permlane32_swap_b32 v113, v115
    v_smfmac_f32_16x16x64_bf16 v[116:119], v[88:91], v[128:135], v218
    v_add_f32 v112, v112, v114
    v_smfmac_f32_16x16x64_bf16 v[120:123], v[64:67], a[48:55], v218
    v_smfmac_f32_16x16x64_bf16 v[120:123], v[68:71], a[104:111], v218
    v_add_f32 v113, v113, v115
    s_waitcnt vmcnt(4)
    v_smfmac_f32_16x16x64_bf16 v[120:123], v[72:75], a[192:199], v218
    ds_write2_b32 v216, v112, v113 offset0:64 offset1:180
    v_smfmac_f32_16x16x64_bf16 v[120:123], v[76:79], a[184:191], v218
    v_smfmac_f32_16x16x64_bf16 v[120:123], v[80:83], v[16:23], v218
    v_permlane32_swap_b32 v116, v118
    s_waitcnt vmcnt(0)
    v_smfmac_f32_16x16x64_bf16 v[120:123], v[84:87], v[24:31], v218
    v_permlane32_swap_b32 v117, v119
    v_smfmac_f32_16x16x64_bf16 v[120:123], v[88:91], v[32:39], v218
    v_add_f32 v116, v116, v118
    v_add_f32 v117, v117, v119
    ds_write2_b32 v216, v116, v117 offset0:80 offset1:196
    s_nop 4
    v_permlane32_swap_b32 v120, v122
    v_permlane32_swap_b32 v121, v123
    v_add_f32 v120, v120, v122
    v_add_f32 v121, v121, v123
    ds_write2_b32 v216, v120, v121 offset0:96 offset1:212
    ds_read_b128 v[64:67], v217 offset:0
    ds_read_b128 v[68:71], v217 offset:16
    ds_read_b128 v[72:75], v217 offset:32
    ds_read_b128 v[76:79], v217 offset:48
    s_mov_b32 vcc_lo, -1
    s_mov_b32 vcc_hi, 0x00ffffff
    s_waitcnt lgkmcnt(2)
    v_pk_add_f32 v[64:65], v[64:65], v[40:41]
    v_pk_add_f32 v[66:67], v[66:67], v[42:43]
    v_pk_add_f32 v[68:69], v[68:69], v[44:45]
    v_pk_add_f32 v[70:71], v[70:71], v[46:47]
    s_waitcnt lgkmcnt(0)
    v_pk_add_f32 v[72:73], v[72:73], v[48:49]
    v_pk_add_f32 v[74:75], v[74:75], v[50:51]
    v_pk_add_f32 v[76:77], v[76:77], v[52:53]
    v_pk_add_f32 v[78:79], v[78:79], v[54:55]
    v_pk_add_f32 v[56:57], v[64:65], v[66:67]
    v_pk_mul_f32 v[58:59], v[64:65], v[64:65]
    v_pk_fma_f32 v[58:59], v[66:67], v[66:67], v[58:59]
    v_pk_add_f32 v[56:57], v[56:57], v[68:69]
    v_pk_fma_f32 v[58:59], v[68:69], v[68:69], v[58:59]
    v_pk_add_f32 v[56:57], v[56:57], v[70:71]
    v_pk_fma_f32 v[58:59], v[70:71], v[70:71], v[58:59]
    v_pk_add_f32 v[56:57], v[56:57], v[72:73]
    v_pk_fma_f32 v[58:59], v[72:73], v[72:73], v[58:59]
    v_pk_add_f32 v[56:57], v[56:57], v[74:75]
    v_pk_fma_f32 v[58:59], v[74:75], v[74:75], v[58:59]
    v_pk_add_f32 v[56:57], v[56:57], v[76:77]
    v_pk_fma_f32 v[58:59], v[76:77], v[76:77], v[58:59]
    v_pk_add_f32 v[56:57], v[56:57], v[78:79]
    v_pk_fma_f32 v[58:59], v[78:79], v[78:79], v[58:59]
    v_add_f32 v14, v56, v57
    v_add_f32 v15, v58, v59
    v_cndmask_b32 v14, 0, v14, vcc
    v_cndmask_b32 v15, 0, v15, vcc
    v_cvt_pk_bf16_f32 v80, v64, v65
    v_cvt_pk_bf16_f32 v81, v66, v67
    v_permlane32_swap_b32 v14, v15
    v_add_f32 v14, v14, v15
    v_mov_b32 v15, v14
    v_cvt_pk_bf16_f32 v82, v68, v69
    v_cvt_pk_bf16_f32 v83, v70, v71
    v_permlane16_swap_b32 v14, v15
    v_add_f32 v14, v14, v15
    v_cvt_pk_bf16_f32 v84, v72, v73
    v_cvt_pk_bf16_f32 v85, v74, v75
    v_add_f32_dpp v14, v14, v14 row_ror:8 row_mask:0xf bank_mask:0xf
    ds_write_b32 v11, v14
    v_cvt_pk_bf16_f32 v86, v76, v77
    v_cvt_pk_bf16_f32 v87, v78, v79
    global_store_dwordx4 v219, v[80:83], s[26:27] offset:0 sc1
    global_store_dwordx4 v219, v[84:87], s[26:27] offset:512 sc1
    s_waitcnt lgkmcnt(0)
    s_barrier
    ds_read_b128 v[56:59], v222
    ds_read_b128 v[60:63], v222 offset:16
    v_mov_b32 v15, 0x3727c5ac
    s_waitcnt lgkmcnt(0)
    v_pk_add_f32 v[56:57], v[56:57], v[58:59]
    v_pk_add_f32 v[60:61], v[60:61], v[62:63]
    v_add_f32 v56, v56, v57
    v_add_f32 v60, v60, v61
    s_add_u32 m0, s58, 86016
    s_nop 0
    buffer_load_dwordx4 v1, s[44:47], m0 offen offset:0 sc1 lds
    buffer_load_dwordx4 v1, s[44:47], m0 offen offset:1024 sc1 lds
    buffer_load_dwordx4 v1, s[44:47], m0 offen offset:2048 sc1 lds
    s_add_u32 m0, s58, 89088
    s_nop 0
    buffer_load_dwordx4 v1, s[44:47], m0 offen offset:0 sc1 lds
    buffer_load_dwordx4 v1, s[44:47], m0 offen offset:1024 sc1 lds
    s_waitcnt vmcnt(0) lgkmcnt(0)
    s_branch L_exact_done
L_e0_spin:
    s_mov_b32 s3, 262144
L_poll_4016:
    s_load_dword s4, s[26:27], s57 offset:0 glc
    s_waitcnt lgkmcnt(0)
    s_cmp_lg_u32 s4, 8
    s_cbranch_scc0 L_polld_4017
    s_sub_u32 s3, s3, 1
    s_cbranch_scc0 L_poll_4016
L_polld_4017:
    s_branch L_e0_ok
L_noe:
    s_nop 15
    s_waitcnt vmcnt(0)
    s_atomic_add s25, s[26:27], s61 offset:8
    s_branch L_done
L_e1_spin:
    s_mov_b32 s3, 262144
L_poll_4020:
    s_load_dword s4, s[26:27], s57 offset:4 glc
    s_waitcnt lgkmcnt(0)
    s_cmp_lg_u32 s4, 8
    s_cbranch_scc0 L_polld_4021
    s_sub_u32 s3, s3, 1
    s_cbranch_scc0 L_poll_4020
L_polld_4021:
    s_branch L_e1_ok
L_e2_spin:
    s_mov_b32 s3, 262144
L_poll_4024:
    s_load_dword s4, s[26:27], s57 offset:8 glc
    s_waitcnt lgkmcnt(0)
    s_cmp_lg_u32 s4, 8
    s_cbranch_scc0 L_polld_4025
    s_sub_u32 s3, s3, 1
    s_cbranch_scc0 L_poll_4024
L_polld_4025:
    s_branch L_e2_ok
L_code_end:
.section .rodata,"a"
.p2align 6
.amdhsa_kernel sequential_preLN__grouped_kv_mqa__geglu_ffn__prompt_kernel
  .amdhsa_next_free_vgpr 512
  .amdhsa_next_free_sgpr 102
  .amdhsa_accum_offset 256
  .amdhsa_group_segment_fixed_size 0
  .amdhsa_kernarg_size 96
  .amdhsa_user_sgpr_count 2
  .amdhsa_user_sgpr_kernarg_segment_ptr 1
  .amdhsa_system_sgpr_workgroup_id_x 1
.end_amdhsa_kernel
```
